```python
import torch

def _softmax(x, axis=-1):
    return torch.softmax(x, dim=axis)
def _gelu(x):
    return torch.nn.functional.gelu(x, approximate="tanh")
def _silu(x):
    return torch.nn.functional.silu(x)
def _sigmoid(x):
    return torch.sigmoid(x)
def _layernorm(x, axis=-1, eps=1e-5):
    m = x.mean(dim=axis, keepdim=True)
    v = x.var(dim=axis, keepdim=True, unbiased=False)
    return (x - m) / torch.sqrt(v + eps)
def _scatter_add(tgt, idx, src, axis=0):
    return tgt.clone().index_add_(axis, idx, src)
def _segment_sum(src, seg, n):
    out = torch.zeros((n,) + src.shape[1:], dtype=src.dtype)
    return out.index_add_(0, seg, src)
def _pad(x, pw):
    flat = tuple(v for pair in reversed(pw) for v in pair)
    return torch.nn.functional.pad(x, flat)

kernel_name = 'recurrent_scan__gqa_block_cached__dense_activation_squared_relu__decode'

def setup_inputs():

    _w = (lambda a: (lambda t: t.to(torch.bfloat16) if t.is_floating_point() else t)(torch.as_tensor(a)))
    def _A_setup():
        B, Sq, D = 4, 1, 512
        Hq, Hkv, Sk, Dh = 32, 8, 16384, 128
        assert Hq % Hkv == 0, (Hq, Hkv)
        return {
            "x": _w((lambda *s: torch.randn(*s, dtype=torch.bfloat16) * 0.05)(B, Sq, D)),
            "k_cache": _w((lambda *s: torch.randn(*s, dtype=torch.bfloat16) * 1.6)(B, Hkv, Sk, Dh)),
            "v_cache": _w((lambda *s: torch.randn(*s, dtype=torch.bfloat16) * 0.2)(B, Hkv, Sk, Dh)),
            "wq": _w((lambda *s: torch.randn(*s, dtype=torch.bfloat16) * 1.6)(D, Hq * Dh) * (D ** -0.5)),
            "wo": _w((lambda *s: torch.randn(*s, dtype=torch.bfloat16) * 0.2)(Hq * Dh, D) * ((Hq * Dh) ** -0.5)),
        }
    _A_in = _A_setup()

    def _B_setup():
        B, S, D, F = 4, 1, 512, 1792
        return {
            "x": _w((lambda *s: torch.randn(*s, dtype=torch.bfloat16) * 0.05)(B, S, D)),
            "w1": _w((lambda *s: torch.randn(*s, dtype=torch.bfloat16) * 0.1)(D, F)),
            "b1": _w((lambda *s: torch.randn(*s, dtype=torch.bfloat16) * 0.1)(F)),
            "w2": _w((lambda *s: torch.randn(*s, dtype=torch.bfloat16) * 0.1)(F, D)),
            "b2": _w((lambda *s: torch.randn(*s, dtype=torch.bfloat16) * 0.1)(D)),
        }
    _B_in = _B_setup()

    return {
        "A_x": _A_in["x"],
        "A_k_cache": _A_in["k_cache"],
        "A_v_cache": _A_in["v_cache"],
        "A_wq": _A_in["wq"],
        "A_wo": _A_in["wo"],
        "B_x": _B_in["x"],
        "B_w1": _B_in["w1"],
        "B_b1": _B_in["b1"],
        "B_w2": _B_in["w2"],
        "B_b2": _B_in["b2"],
    }

def reference(A_x, A_k_cache, A_v_cache, A_wq, A_wo, B_x, B_w1, B_b1, B_w2, B_b2):
    def _A_ref(x, k_cache, v_cache, wq, wo):
        B, Sq, D = x.shape
        Hq, Dh = 32, 128
        Hkv = k_cache.shape[1]
        rep = Hq // Hkv
        q = (lambda x, *d: x.permute(*d))((x @ wq).reshape(B, Sq, Hq, Dh), 0, 2, 1, 3)
        k = (lambda x, n, axis: torch.repeat_interleave(x, n, dim=axis))(k_cache, rep, axis=1)
        v = (lambda x, n, axis: torch.repeat_interleave(x, n, dim=axis))(v_cache, rep, axis=1)
        scores = torch.einsum("bhqd,bhkd->bhqk", q, k) * (Dh ** -0.5)
        p = _softmax(scores, axis=-1)
        o = torch.einsum("bhqk,bhkd->bhqd", p, v)
        return (lambda x, *d: x.permute(*d))(o, 0, 2, 1, 3).reshape(B, Sq, Hq * Dh) @ wo

    def _B_ref(x, w1, b1, w2, b2):
        h = torch.einsum("bsd,df->bsf", x, w1) + b1
        zero = torch.zeros_like(h)
        r = torch.where(h > zero, h, zero)
        h = r * r
        out = torch.einsum("bsf,fd->bsd", h, w2) + b2
        return out

    x = A_x
    xn = _layernorm(x, axis=-1)
    s = _A_ref(xn, A_k_cache, A_v_cache, A_wq, A_wo)
    g = _silu(_B_ref(xn, B_w1, B_b1, B_w2, B_b2))
    return x + s * g
```

```asm
; @launch grid=(256,1,1) block=(512,1,1) lds=137216
.amdgcn_target "amdgcn-amd-amdhsa--gfx950"
.text
.globl recurrent_scan__gqa_block_cached__dense_activation_squared_relu__decode_kernel
.p2align 8
.type recurrent_scan__gqa_block_cached__dense_activation_squared_relu__decode_kernel,@function
recurrent_scan__gqa_block_cached__dense_activation_squared_relu__decode_kernel:
  s_cmp_ge_u32 s2, 256
  s_cbranch_scc1 L_end
  s_load_dwordx16 s[4:19], s[0:1], 0
  s_load_dwordx8 s[20:27], s[0:1], 64
  s_load_dwordx2 s[28:29], s[0:1], 96
  s_memrealtime s[88:89]
  v_and_b32 v1, 63, v0
  v_lshrrev_b32 v2, 6, v0
  s_nop 0
  v_readfirstlane_b32 s3, v2
  v_mov_b32 v4, 0
  v_mov_b32 v5, 0
  v_mov_b32 v6, 0
  v_mov_b32 v7, 0
  ds_write_b128 v4, v[4:7] offset:5120
  ds_write_b128 v4, v[4:7] offset:5136
  s_and_b32 s30, s2, 7
  s_lshr_b32 s31, s2, 3
  s_lshr_b32 s62, s31, 3
  s_and_b32 s63, s31, 7
  s_sub_u32 s67, s30, s31
  s_and_b32 s67, s67, 7
  v_lshlrev_b32 v3, 4, v1
  s_cmp_ge_u32 s3, 4
  s_cbranch_scc1 L_stream
  s_setprio 3
  s_lshl_b32 s64, s3, 10
  s_lshl_b32 s65, s63, 3
  s_add_u32 s65, s65, s30
  s_mov_b32 s66, s62
  v_lshrrev_b32 v4, 3, v1
  v_and_b32 v5, 7, v1
  v_lshlrev_b32 v5, 4, v5
  v_lshrrev_b32 v7, 4, v1
  v_lshlrev_b32 v50, 10, v7
  v_lshlrev_b32 v51, 4, v7
  v_bfe_u32 v47, v1, 2, 2
  v_lshlrev_b32 v7, 7, v47
  v_add_u32 v50, v50, v7
  v_and_b32 v46, 3, v1
  v_lshlrev_b32 v49, 3, v46
  v_add_u32 v50, v50, v49
  v_lshlrev_b32 v48, 10, v46
  v_add_u32 v48, v48, v51
  v_mov_b32 v56, 0
  s_mov_b32 s68, 3
  s_cmp_eq_u32 s67, 3
  s_cselect_b32 s68, 2, s68
  s_mov_b32 s83, 0xff010003
  s_lshr_b32 s69, s31, 2
  s_cmp_eq_u32 s69, 1
  s_cselect_b32 s83, 0xb040207, s83
  s_cmp_eq_u32 s69, 2
  s_cselect_b32 s83, 0xff0f0605, s83
  s_cmp_eq_u32 s69, 3
  s_cselect_b32 s83, 0xa130908, s83
  s_cmp_eq_u32 s69, 4
  s_cselect_b32 s83, 0xff0d170c, s83
  s_cmp_eq_u32 s69, 5
  s_cselect_b32 s83, 0x11101b0e, s83
  s_cmp_eq_u32 s69, 6
  s_cselect_b32 s83, 0xff151412, s83
  s_cmp_eq_u32 s69, 7
  s_cselect_b32 s83, 0x1a191816, s83
  s_and_b32 s69, s31, 3
  s_lshl_b32 s69, s69, 3
  s_lshr_b32 s83, s83, s69
  s_and_b32 s83, s83, 0xff
  s_cmp_lt_u32 s83, 28
  s_cselect_b32 s69, 1, 3
  s_cmp_eq_u32 s67, 2
  s_cselect_b32 s68, s69, s68
  s_cmp_lt_u32 s67, 2
  s_cselect_b32 s68, 0, s68
  s_lshl_b32 s70, s3, 14
  s_add_u32 s71, s70, 37888
  s_waitcnt lgkmcnt(0)
  s_mov_b32 s56, s4
  s_and_b32 s57, s5, 0xffff
  s_mov_b32 s58, 0x1000
  s_mov_b32 s59, 0x20000
  s_mov_b32 s40, s28
  s_and_b32 s41, s29, 0xffff
  s_mov_b32 s42, 0x20000000
  s_mov_b32 s43, 0x20000
  s_mov_b32 s44, s26
  s_and_b32 s45, s27, 0xffff
  s_mov_b32 s46, 0x100
  s_mov_b32 s47, 0x20000
  s_cmp_ge_u32 s68, 2
  s_cbranch_scc1 L_plain
  s_cmp_lg_u32 s3, 3
  s_cbranch_scc1 L_nocnt
  s_cmp_lg_u32 s67, 0
  s_cbranch_scc1 L_nocnt
  s_lshl_b32 s69, s31, 8
  s_add_u32 s69, s69, 131072
  s_mov_b64 exec, 1
  buffer_store_dword v56, v56, s[40:43], s69 offen sc1
  s_mov_b64 exec, -1
L_nocnt:
  buffer_load_dwordx4 v[8:11], v3, s[56:59], s64 offen
  s_mov_b32 m0, s71
  s_cmp_eq_u32 s68, 1
  s_cbranch_scc1 L_w1
  s_mov_b32 s48, s10
  s_and_b32 s49, s11, 0xffff
  s_mov_b32 s50, 0x400000
  s_mov_b32 s51, 0x20000
  v_lshl_add_u32 v6, v4, 13, v5
  s_lshl_b32 s72, s62, 1
  s_add_u32 s72, s72, s67
  s_xor_b32 s72, s72, 4
  s_lshl_b32 s73, s63, 3
  s_add_u32 s72, s72, s73
  s_lshl_b32 s69, s72, 7
  s_lshl_b32 s70, s3, 20
  s_add_u32 s69, s69, s70
  s_mov_b32 s79, 65536
  s_branch L_bigdma
L_w1:
  s_mov_b32 s48, s16
  s_and_b32 s49, s17, 0xffff
  s_mov_b32 s50, 0x1c0000
  s_mov_b32 s51, 0x20000
  s_movk_i32 s69, 3584
  v_mul_lo_u32 v6, v4, s69
  v_add_u32 v6, v6, v5
  s_mov_b32 s72, s83
  s_lshl_b32 s69, s72, 7
  s_mul_i32 s70, s3, 458752
  s_add_u32 s69, s69, s70
  s_mov_b32 s79, 28672
L_bigdma:
  buffer_load_dwordx4 v6, s[48:51], s69 offen nt lds
  s_add_u32 s69, s69, s79
  s_add_u32 m0, m0, 1024
  s_nop 0
  buffer_load_dwordx4 v6, s[48:51], s69 offen nt lds
  s_add_u32 s69, s69, s79
  s_add_u32 m0, m0, 1024
  s_nop 0
  buffer_load_dwordx4 v6, s[48:51], s69 offen nt lds
  s_add_u32 s69, s69, s79
  s_add_u32 m0, m0, 1024
  s_nop 0
  buffer_load_dwordx4 v6, s[48:51], s69 offen nt lds
  s_add_u32 s69, s69, s79
  s_add_u32 m0, m0, 1024
  s_nop 0
  buffer_load_dwordx4 v6, s[48:51], s69 offen nt lds
  s_add_u32 s69, s69, s79
  s_add_u32 m0, m0, 1024
  s_nop 0
  buffer_load_dwordx4 v6, s[48:51], s69 offen nt lds
  s_add_u32 s69, s69, s79
  s_add_u32 m0, m0, 1024
  s_nop 0
  buffer_load_dwordx4 v6, s[48:51], s69 offen nt lds
  s_add_u32 s69, s69, s79
  s_add_u32 m0, m0, 1024
  s_nop 0
  buffer_load_dwordx4 v6, s[48:51], s69 offen nt lds
  s_add_u32 s69, s69, s79
  s_add_u32 m0, m0, 1024
  s_nop 0
  buffer_load_dwordx4 v6, s[48:51], s69 offen nt lds
  s_add_u32 s69, s69, s79
  s_add_u32 m0, m0, 1024
  s_nop 0
  buffer_load_dwordx4 v6, s[48:51], s69 offen nt lds
  s_add_u32 s69, s69, s79
  s_add_u32 m0, m0, 1024
  s_nop 0
  buffer_load_dwordx4 v6, s[48:51], s69 offen nt lds
  s_add_u32 s69, s69, s79
  s_add_u32 m0, m0, 1024
  s_nop 0
  buffer_load_dwordx4 v6, s[48:51], s69 offen nt lds
  s_add_u32 s69, s69, s79
  s_add_u32 m0, m0, 1024
  s_nop 0
  buffer_load_dwordx4 v6, s[48:51], s69 offen nt lds
  s_add_u32 s69, s69, s79
  s_add_u32 m0, m0, 1024
  s_nop 0
  buffer_load_dwordx4 v6, s[48:51], s69 offen nt lds
  s_add_u32 s69, s69, s79
  s_add_u32 m0, m0, 1024
  s_nop 0
  buffer_load_dwordx4 v6, s[48:51], s69 offen nt lds
  s_add_u32 s69, s69, s79
  s_add_u32 m0, m0, 1024
  s_nop 0
  buffer_load_dwordx4 v6, s[48:51], s69 offen nt lds
  buffer_load_dwordx2 v[58:59], v56, s[44:47], 0 offen sc1
  s_mov_b32 s52, s18
  s_and_b32 s53, s19, 0xffff
  s_mov_b32 s54, 0xe00
  s_mov_b32 s55, 0x20000
  v_lshlrev_b32 v7, 5, v47
  v_lshrrev_b32 v12, 1, v51
  v_add_u32 v7, v7, v12
  s_lshl_b32 s69, s83, 7
  s_min_u32 s69, s69, 3456
  buffer_load_dwordx2 v[54:55], v7, s[52:55], s69 offen
  s_barrier
  s_waitcnt vmcnt(18)
  v_lshlrev_b32 v20, 16, v8
  v_and_b32 v21, 0xffff0000, v8
  v_lshlrev_b32 v22, 16, v9
  v_and_b32 v23, 0xffff0000, v9
  v_lshlrev_b32 v24, 16, v10
  v_and_b32 v25, 0xffff0000, v10
  v_lshlrev_b32 v26, 16, v11
  v_and_b32 v27, 0xffff0000, v11
  v_add_f32 v28, v20, v21
  v_add_f32 v29, v22, v23
  v_add_f32 v30, v24, v25
  v_add_f32 v31, v26, v27
  v_add_f32 v28, v28, v29
  v_add_f32 v30, v30, v31
  v_add_f32 v28, v28, v30
  s_nop 1
  v_add_f32_dpp v28, v28, v28 row_ror:8 row_mask:0xf bank_mask:0xf
  s_nop 1
  v_add_f32_dpp v28, v28, v28 row_ror:4 row_mask:0xf bank_mask:0xf
  s_nop 1
  v_add_f32_dpp v28, v28, v28 row_ror:2 row_mask:0xf bank_mask:0xf
  s_nop 1
  v_add_f32_dpp v28, v28, v28 row_ror:1 row_mask:0xf bank_mask:0xf
  v_mov_b32 v29, v28
  s_nop 1
  v_permlane16_swap_b32 v28, v29
  v_add_f32 v28, v28, v29
  v_mov_b32 v29, v28
  s_nop 1
  v_permlane32_swap_b32 v28, v29
  v_add_f32 v28, v28, v29
  v_mul_f32 v28, 0x3b000000, v28
  v_sub_f32 v32, v20, v28
  v_sub_f32 v33, v21, v28
  v_sub_f32 v34, v22, v28
  v_sub_f32 v35, v23, v28
  v_sub_f32 v36, v24, v28
  v_sub_f32 v37, v25, v28
  v_sub_f32 v38, v26, v28
  v_sub_f32 v39, v27, v28
  v_mul_f32 v30, v32, v32
  v_fmac_f32 v30, v33, v33
  v_fmac_f32 v30, v34, v34
  v_fmac_f32 v30, v35, v35
  v_fmac_f32 v30, v36, v36
  v_fmac_f32 v30, v37, v37
  v_fmac_f32 v30, v38, v38
  v_fmac_f32 v30, v39, v39
  s_nop 1
  v_add_f32_dpp v30, v30, v30 row_ror:8 row_mask:0xf bank_mask:0xf
  s_nop 1
  v_add_f32_dpp v30, v30, v30 row_ror:4 row_mask:0xf bank_mask:0xf
  s_nop 1
  v_add_f32_dpp v30, v30, v30 row_ror:2 row_mask:0xf bank_mask:0xf
  s_nop 1
  v_add_f32_dpp v30, v30, v30 row_ror:1 row_mask:0xf bank_mask:0xf
  v_mov_b32 v29, v30
  s_nop 1
  v_permlane16_swap_b32 v30, v29
  v_add_f32 v30, v30, v29
  v_mov_b32 v29, v30
  s_nop 1
  v_permlane32_swap_b32 v30, v29
  v_add_f32 v30, v30, v29
  v_mul_f32 v30, 0x3b000000, v30
  v_cvt_pk_bf16_f32 v29, v28, v28
  v_lshlrev_b32 v28, 16, v29
  v_cvt_pk_bf16_f32 v29, v30, v30
  v_lshlrev_b32 v30, 16, v29
  v_add_f32 v30, 0x3727c5ac, v30
  v_cvt_pk_bf16_f32 v29, v30, v30
  v_lshlrev_b32 v30, 16, v29
  v_sqrt_f32 v30, v30
  s_nop 0
  v_cvt_pk_bf16_f32 v29, v30, v30
  v_lshlrev_b32 v30, 16, v29
  v_rcp_f32 v31, v30
  v_sub_f32 v20, v20, v28
  v_sub_f32 v21, v21, v28
  v_sub_f32 v22, v22, v28
  v_sub_f32 v23, v23, v28
  v_sub_f32 v24, v24, v28
  v_sub_f32 v25, v25, v28
  v_sub_f32 v26, v26, v28
  v_sub_f32 v27, v27, v28
  v_cvt_pk_bf16_f32 v32, v20, v21
  v_cvt_pk_bf16_f32 v33, v22, v23
  v_lshlrev_b32 v20, 16, v32
  v_and_b32 v21, 0xffff0000, v32
  v_lshlrev_b32 v22, 16, v33
  v_and_b32 v23, 0xffff0000, v33
  v_cvt_pk_bf16_f32 v34, v24, v25
  v_cvt_pk_bf16_f32 v35, v26, v27
  v_lshlrev_b32 v24, 16, v34
  v_and_b32 v25, 0xffff0000, v34
  v_lshlrev_b32 v26, 16, v35
  v_and_b32 v27, 0xffff0000, v35
  v_mul_f32 v32, v20, v31
  v_mul_f32 v33, v21, v31
  v_mul_f32 v34, v22, v31
  v_mul_f32 v35, v23, v31
  v_mul_f32 v36, v24, v31
  v_mul_f32 v37, v25, v31
  v_mul_f32 v38, v26, v31
  v_mul_f32 v39, v27, v31
  v_fma_f32 v20, -v32, v30, v20
  v_fma_f32 v21, -v33, v30, v21
  v_fma_f32 v22, -v34, v30, v22
  v_fma_f32 v23, -v35, v30, v23
  v_fma_f32 v24, -v36, v30, v24
  v_fma_f32 v25, -v37, v30, v25
  v_fma_f32 v26, -v38, v30, v26
  v_fma_f32 v27, -v39, v30, v27
  v_fmac_f32 v32, v20, v31
  v_fmac_f32 v33, v21, v31
  v_fmac_f32 v34, v22, v31
  v_fmac_f32 v35, v23, v31
  v_fmac_f32 v36, v24, v31
  v_fmac_f32 v37, v25, v31
  v_fmac_f32 v38, v26, v31
  v_fmac_f32 v39, v27, v31
  v_cvt_pk_bf16_f32 v40, v32, v33
  v_cvt_pk_bf16_f32 v41, v34, v35
  v_cvt_pk_bf16_f32 v42, v36, v37
  v_cvt_pk_bf16_f32 v43, v38, v39
  v_add_u32 v29, s64, v3
  ds_write_b128 v29, v[40:43] offset:0
  s_waitcnt lgkmcnt(0)
L_gemv:
  v_mov_b32 v16, 1
  v_mov_b32 v17, 0
  s_mov_b64 exec, 1
  ds_add_u32 v17, v16 offset:5120
  s_mov_b64 exec, -1
  s_lshl_b32 s69, s3, 8
  v_add_u32 v20, s69, v48
  v_add_u32 v21, s71, v50
  v_cmp_eq_u32 s[74:75], 1, v47
  v_cmp_eq_u32 s[76:77], 2, v47
  v_cmp_eq_u32 s[80:81], 3, v47
  v_mov_b32 v17, 0
  s_mov_b32 s60, 480000
L_ll1:
  ds_read_b32 v16, v17 offset:5120
  s_waitcnt lgkmcnt(0)
  v_readfirstlane_b32 s61, v16
  s_cmp_ge_u32 s61, 4
  s_cbranch_scc1 L_lg2
  s_sub_u32 s60, s60, 1
  s_cmp_lg_u32 s60, 0
  s_cbranch_scc1 L_ll1
L_lg2:
  ds_read_b128 v[64:67], v20 offset:0
  ds_read_b128 v[68:71], v20 offset:64
  ds_read_b128 v[72:75], v20 offset:128
  ds_read_b128 v[76:79], v20 offset:192
  s_waitcnt vmcnt(0)
  ds_read_b64_tr_b16 v[128:129], v21 offset:0
  ds_read_b64_tr_b16 v[130:131], v21 offset:512
  ds_read_b64_tr_b16 v[144:145], v21 offset:32
  ds_read_b64_tr_b16 v[146:147], v21 offset:544
  ds_read_b64_tr_b16 v[160:161], v21 offset:64
  ds_read_b64_tr_b16 v[162:163], v21 offset:576
  ds_read_b64_tr_b16 v[176:177], v21 offset:96
  ds_read_b64_tr_b16 v[178:179], v21 offset:608
  ds_read_b64_tr_b16 v[132:133], v21 offset:4096
  ds_read_b64_tr_b16 v[134:135], v21 offset:4608
  ds_read_b64_tr_b16 v[148:149], v21 offset:4128
  ds_read_b64_tr_b16 v[150:151], v21 offset:4640
  ds_read_b64_tr_b16 v[164:165], v21 offset:4160
  ds_read_b64_tr_b16 v[166:167], v21 offset:4672
  ds_read_b64_tr_b16 v[180:181], v21 offset:4192
  ds_read_b64_tr_b16 v[182:183], v21 offset:4704
  s_waitcnt lgkmcnt(8)
  v_mfma_f32_16x16x32_bf16 v[96:99], v[128:131], v[64:67], 0
  v_mfma_f32_16x16x32_bf16 v[100:103], v[144:147], v[64:67], 0
  v_mfma_f32_16x16x32_bf16 v[104:107], v[160:163], v[64:67], 0
  v_mfma_f32_16x16x32_bf16 v[108:111], v[176:179], v[64:67], 0
  ds_read_b64_tr_b16 v[136:137], v21 offset:8192
  ds_read_b64_tr_b16 v[138:139], v21 offset:8704
  ds_read_b64_tr_b16 v[152:153], v21 offset:8224
  ds_read_b64_tr_b16 v[154:155], v21 offset:8736
  ds_read_b64_tr_b16 v[168:169], v21 offset:8256
  ds_read_b64_tr_b16 v[170:171], v21 offset:8768
  ds_read_b64_tr_b16 v[184:185], v21 offset:8288
  ds_read_b64_tr_b16 v[186:187], v21 offset:8800
  s_waitcnt lgkmcnt(8)
  v_mfma_f32_16x16x32_bf16 v[96:99], v[132:135], v[68:71], v[96:99]
  v_mfma_f32_16x16x32_bf16 v[100:103], v[148:151], v[68:71], v[100:103]
  v_mfma_f32_16x16x32_bf16 v[104:107], v[164:167], v[68:71], v[104:107]
  v_mfma_f32_16x16x32_bf16 v[108:111], v[180:183], v[68:71], v[108:111]
  ds_read_b64_tr_b16 v[140:141], v21 offset:12288
  ds_read_b64_tr_b16 v[142:143], v21 offset:12800
  ds_read_b64_tr_b16 v[156:157], v21 offset:12320
  ds_read_b64_tr_b16 v[158:159], v21 offset:12832
  ds_read_b64_tr_b16 v[172:173], v21 offset:12352
  ds_read_b64_tr_b16 v[174:175], v21 offset:12864
  ds_read_b64_tr_b16 v[188:189], v21 offset:12384
  ds_read_b64_tr_b16 v[190:191], v21 offset:12896
  s_waitcnt lgkmcnt(8)
  v_mfma_f32_16x16x32_bf16 v[96:99], v[136:139], v[72:75], v[96:99]
  v_mfma_f32_16x16x32_bf16 v[100:103], v[152:155], v[72:75], v[100:103]
  v_mfma_f32_16x16x32_bf16 v[104:107], v[168:171], v[72:75], v[104:107]
  v_mfma_f32_16x16x32_bf16 v[108:111], v[184:187], v[72:75], v[108:111]
  s_waitcnt lgkmcnt(0)
  v_mfma_f32_16x16x32_bf16 v[96:99], v[140:143], v[76:79], v[96:99]
  v_mfma_f32_16x16x32_bf16 v[100:103], v[156:159], v[76:79], v[100:103]
  v_mfma_f32_16x16x32_bf16 v[104:107], v[172:175], v[76:79], v[104:107]
  v_mfma_f32_16x16x32_bf16 v[108:111], v[188:191], v[76:79], v[108:111]
  s_nop 5
  v_cndmask_b32 v96, v96, v100, s[74:75]
  v_cndmask_b32 v97, v97, v101, s[74:75]
  v_cndmask_b32 v98, v98, v102, s[74:75]
  v_cndmask_b32 v99, v99, v103, s[74:75]
  v_cndmask_b32 v96, v96, v104, s[76:77]
  v_cndmask_b32 v97, v97, v105, s[76:77]
  v_cndmask_b32 v98, v98, v106, s[76:77]
  v_cndmask_b32 v99, v99, v107, s[76:77]
  v_cndmask_b32 v96, v96, v108, s[80:81]
  v_cndmask_b32 v97, v97, v109, s[80:81]
  v_cndmask_b32 v98, v98, v110, s[80:81]
  v_cndmask_b32 v99, v99, v111, s[80:81]
L_gemvz:
  v_add_u32 v29, s64, v3
  ds_write_b128 v29, v[96:99] offset:17408
  s_waitcnt lgkmcnt(0)
  v_mov_b32 v16, 1
  v_mov_b32 v17, 0
  s_mov_b64 exec, 1
  ds_add_u32 v17, v16 offset:5124
  s_mov_b64 exec, -1
  s_cmp_lg_u32 s3, 0
  s_cbranch_scc1 L_gdone
  s_cmp_eq_u32 s68, 2
  s_cbranch_scc1 L_havet
  s_mov_b32 s60, 60000
L_nl:
  v_cmp_ne_u64 vcc, 0, v[58:59]
  s_cbranch_vccnz L_nd
  s_sleep 1
  buffer_load_dwordx2 v[58:59], v56, s[44:47], 0 offen sc1
  s_waitcnt vmcnt(0)
  s_sub_u32 s60, s60, 1
  s_cmp_lg_u32 s60, 0
  s_cbranch_scc1 L_nl
L_nd:
  ds_write_b64 v56, v[58:59] offset:5152
  v_mov_b32 v61, 0xfffffc00
  v_readfirstlane_b32 s86, v58
  v_readfirstlane_b32 s87, v59
  s_lshr_b32 s84, s86, 22
  s_bfe_u32 s85, s86, 655372
  s_bfe_u32 s86, s86, 655362
  s_and_b32 s87, s87, 1023
L_havet:
  v_lshl_add_u32 v22, v47, 6, v51
  v_mov_b32 v17, 0
  s_mov_b32 s60, 480000
L_ll3:
  ds_read_b32 v16, v17 offset:5124
  s_waitcnt lgkmcnt(0)
  v_readfirstlane_b32 s61, v16
  s_cmp_ge_u32 s61, 4
  s_cbranch_scc1 L_lg4
  s_sub_u32 s60, s60, 1
  s_cmp_lg_u32 s60, 0
  s_cbranch_scc1 L_ll3
L_lg4:
  ds_read_b128 v[100:103], v3 offset:18432
  ds_read_b128 v[104:107], v3 offset:19456
  ds_read_b128 v[108:111], v3 offset:20480
  s_waitcnt lgkmcnt(0)
  v_add_f32 v96, v96, v100
  v_add_f32 v104, v104, v108
  v_add_f32 v97, v97, v101
  v_add_f32 v105, v105, v109
  v_add_f32 v98, v98, v102
  v_add_f32 v106, v106, v110
  v_add_f32 v99, v99, v103
  v_add_f32 v107, v107, v111
  v_add_f32 v96, v96, v104
  v_add_f32 v97, v97, v105
  v_add_f32 v98, v98, v106
  v_add_f32 v99, v99, v107
  s_cmp_eq_u32 s68, 2
  s_cbranch_scc1 L_ep2
  v_cvt_pk_bf16_f32 v36, v96, v97
  v_cvt_pk_bf16_f32 v37, v98, v99
  v_lshlrev_b32 v96, 16, v36
  v_and_b32 v97, 0xffff0000, v36
  v_lshlrev_b32 v98, 16, v37
  v_and_b32 v99, 0xffff0000, v37
  s_lshl_b32 s69, s72, 8
  s_cmp_eq_u32 s68, 1
  s_cbranch_scc1 L_ep1
  v_lshl_add_u32 v22, v46, 14, v22
  s_branch L_eppub
L_ep1:
  v_lshlrev_b32 v40, 16, v54
  v_and_b32 v41, 0xffff0000, v54
  v_lshlrev_b32 v42, 16, v55
  v_and_b32 v43, 0xffff0000, v55
  v_add_f32 v96, v96, v40
  v_add_f32 v97, v97, v41
  v_add_f32 v98, v98, v42
  v_add_f32 v99, v99, v43
  v_cvt_pk_bf16_f32 v36, v96, v97
  v_cvt_pk_bf16_f32 v37, v98, v99
  v_lshlrev_b32 v96, 16, v36
  v_and_b32 v97, 0xffff0000, v36
  v_lshlrev_b32 v98, 16, v37
  v_and_b32 v99, 0xffff0000, v37
  v_max_f32 v96, 0, v96
  v_max_f32 v97, 0, v97
  v_max_f32 v98, 0, v98
  v_max_f32 v99, 0, v99
  v_mul_f32 v96, v96, v96
  v_mul_f32 v97, v97, v97
  v_mul_f32 v98, v98, v98
  v_mul_f32 v99, v99, v99
  v_cvt_pk_bf16_f32 v36, v96, v97
  v_cvt_pk_bf16_f32 v37, v98, v99
  v_lshlrev_b32 v96, 16, v36
  v_and_b32 v97, 0xffff0000, v36
  v_lshlrev_b32 v98, 16, v37
  v_and_b32 v99, 0xffff0000, v37
  v_lshl_add_u32 v22, v46, 13, v22
  s_add_u32 s69, s69, 65536
  s_branch L_eppub
L_ep2:
  v_lshl_add_u32 v22, v46, 11, v22
  s_lshl_b32 s69, s62, 13
  s_lshl_b32 s70, s63, 8
  s_add_u32 s69, s69, s70
  s_add_u32 s69, s69, 98304
L_eppub:
  v_add_u32 v96, 512, v96
  v_add_u32 v97, 512, v97
  v_add_u32 v98, 512, v98
  v_add_u32 v99, 512, v99
  v_and_or_b32 v96, v96, v61, s84
  v_and_or_b32 v97, v97, v61, s85
  v_and_or_b32 v98, v98, v61, s86
  v_and_or_b32 v99, v99, v61, s87
  buffer_store_dwordx4 v[96:99], v22, s[40:43], s69 offen sc1
L_gdone:
  s_cmp_eq_u32 s68, 2
  s_cbranch_scc1 L_post
  s_cmp_lg_u32 s3, 0
  s_cbranch_scc1 L_b1
  s_sleep 80
  s_branch L_qpoll
L_plain:
  s_cmp_lg_u32 s2, 7
  s_cbranch_scc1 L_noinit
  s_cmp_lg_u32 s3, 0
  s_cbranch_scc1 L_noinit
  s_mul_i32 s72, s88, 0x9e3779b1
  s_and_b32 s73, s89, 0xff
  s_lshl_b32 s73, s73, 2
  s_and_b32 s74, s72, 3
  s_or_b32 s73, s73, s74
  s_bfe_u32 s74, s72, 655377
  s_xor_b32 s73, s73, s74
  s_or_b32 s73, s73, 0x80000000
  v_mov_b32 v16, s72
  v_mov_b32 v17, s73
  v_mov_b32 v18, 0
  v_mov_b32 v19, 0
  s_mov_b64 exec, 1
  buffer_atomic_cmpswap_x2 v[16:19], v56, s[44:47], 0 offen sc1
  s_mov_b64 exec, -1
L_noinit:
  s_barrier
  s_cmp_lg_u32 s3, 0
  s_cbranch_scc1 L_b1
  s_sleep 24
  s_mov_b32 s60, 60000
L_nl2:
  buffer_load_dwordx2 v[58:59], v56, s[44:47], 0 offen sc1
  s_waitcnt vmcnt(0)
  v_cmp_ne_u64 vcc, 0, v[58:59]
  s_cbranch_vccnz L_nd2
  s_sleep 2
  s_sub_u32 s60, s60, 1
  s_cmp_lg_u32 s60, 0
  s_cbranch_scc1 L_nl2
L_nd2:
  ds_write_b64 v56, v[58:59] offset:5152
  v_mov_b32 v61, 0xfffffc00
  v_readfirstlane_b32 s86, v58
  v_readfirstlane_b32 s87, v59
  s_lshr_b32 s84, s86, 22
  s_bfe_u32 s85, s86, 655372
  s_bfe_u32 s86, s86, 655362
  s_and_b32 s87, s87, 1023
  s_sleep 110
L_qpoll:
  s_lshl_b32 s69, s31, 11
  s_mov_b32 s60, 60000
L_pl5:
  buffer_load_dwordx4 v[64:67], v3, s[40:43], s69 offen offset:0 sc1
  buffer_load_dwordx4 v[68:71], v3, s[40:43], s69 offen offset:1024 sc1
L_pc7:
  s_waitcnt vmcnt(0)
  v_xor_b32 v64, s84, v64
  v_xor_b32 v65, s85, v65
  v_xor_b32 v66, s86, v66
  v_xor_b32 v67, s87, v67
  v_xor_b32 v68, s84, v68
  v_xor_b32 v69, s85, v69
  v_xor_b32 v70, s86, v70
  v_xor_b32 v71, s87, v71
  v_or3_b32 v40, v64, v65, v66
  v_or3_b32 v40, v40, v67, v68
  v_or3_b32 v40, v40, v69, v70
  v_or_b32 v40, v40, v71
  v_and_b32 v40, 1023, v40
  v_cmp_ne_u32 vcc, 0, v40
  s_cbranch_vccz L_pd6
  s_sleep 4
  s_sub_u32 s60, s60, 1
  s_cmp_lg_u32 s60, 0
  s_cbranch_scc1 L_pl5
L_pd6:
  s_nop 1
  v_lshlrev_b32 v40, 3, v1
  s_mov_b32 s61, 0x07060302
  v_perm_b32 v36, v65, v64, s61
  v_perm_b32 v37, v67, v66, s61
  v_perm_b32 v38, v69, v68, s61
  v_perm_b32 v39, v71, v70, s61
  ds_write_b64 v40, v[36:37] offset:4096
  ds_write_b64 v40, v[38:39] offset:4608
L_b1:
  s_waitcnt vmcnt(0) lgkmcnt(0)
  s_barrier
  s_setprio 1
  v_mov_b32 v60, 0
  ds_read_b64 v[58:59], v60 offset:5152
  s_waitcnt lgkmcnt(0)
  v_mov_b32 v61, 0xfffffc00
  v_readfirstlane_b32 s86, v58
  v_readfirstlane_b32 s87, v59
  s_lshr_b32 s84, s86, 22
  s_bfe_u32 s85, s86, 655372
  s_bfe_u32 s86, s86, 655362
  s_and_b32 s87, s87, 1023
  s_cmp_lg_u32 s68, 2
  s_cbranch_scc1 L_post
  v_mov_b32 v96, 0
  v_mov_b32 v97, 0
  v_mov_b32 v98, 0
  v_mov_b32 v99, 0
  s_lshl_b32 s69, s62, 2
  s_add_u32 s69, s69, s3
  s_cmp_ge_u32 s69, 14
  s_cselect_b32 s78, 1, 0
  s_cbranch_scc1 L_now2
  s_mov_b32 s48, s20
  s_and_b32 s49, s21, 0xffff
  s_mov_b32 s50, 0x1c0000
  s_mov_b32 s51, 0x20000
  s_lshl_b32 s69, s69, 17
  s_lshl_b32 s70, s63, 7
  s_add_u32 s69, s69, s70
  s_mov_b32 m0, s71
  v_lshl_add_u32 v6, v4, 10, v5
  buffer_load_dwordx4 v6, s[48:51], s69 offen nt lds
  s_add_u32 s69, s69, 8192
  s_add_u32 m0, m0, 1024
  s_nop 0
  buffer_load_dwordx4 v6, s[48:51], s69 offen nt lds
  s_add_u32 s69, s69, 8192
  s_add_u32 m0, m0, 1024
  s_nop 0
  buffer_load_dwordx4 v6, s[48:51], s69 offen nt lds
  s_add_u32 s69, s69, 8192
  s_add_u32 m0, m0, 1024
  s_nop 0
  buffer_load_dwordx4 v6, s[48:51], s69 offen nt lds
  s_add_u32 s69, s69, 8192
  s_add_u32 m0, m0, 1024
  s_nop 0
  buffer_load_dwordx4 v6, s[48:51], s69 offen nt lds
  s_add_u32 s69, s69, 8192
  s_add_u32 m0, m0, 1024
  s_nop 0
  buffer_load_dwordx4 v6, s[48:51], s69 offen nt lds
  s_add_u32 s69, s69, 8192
  s_add_u32 m0, m0, 1024
  s_nop 0
  buffer_load_dwordx4 v6, s[48:51], s69 offen nt lds
  s_add_u32 s69, s69, 8192
  s_add_u32 m0, m0, 1024
  s_nop 0
  buffer_load_dwordx4 v6, s[48:51], s69 offen nt lds
  s_add_u32 s69, s69, 8192
  s_add_u32 m0, m0, 1024
  s_nop 0
  buffer_load_dwordx4 v6, s[48:51], s69 offen nt lds
  s_add_u32 s69, s69, 8192
  s_add_u32 m0, m0, 1024
  s_nop 0
  buffer_load_dwordx4 v6, s[48:51], s69 offen nt lds
  s_add_u32 s69, s69, 8192
  s_add_u32 m0, m0, 1024
  s_nop 0
  buffer_load_dwordx4 v6, s[48:51], s69 offen nt lds
  s_add_u32 s69, s69, 8192
  s_add_u32 m0, m0, 1024
  s_nop 0
  buffer_load_dwordx4 v6, s[48:51], s69 offen nt lds
  s_add_u32 s69, s69, 8192
  s_add_u32 m0, m0, 1024
  s_nop 0
  buffer_load_dwordx4 v6, s[48:51], s69 offen nt lds
  s_add_u32 s69, s69, 8192
  s_add_u32 m0, m0, 1024
  s_nop 0
  buffer_load_dwordx4 v6, s[48:51], s69 offen nt lds
  s_add_u32 s69, s69, 8192
  s_add_u32 m0, m0, 1024
  s_nop 0
  buffer_load_dwordx4 v6, s[48:51], s69 offen nt lds
  s_add_u32 s69, s69, 8192
  s_add_u32 m0, m0, 1024
  s_nop 0
  buffer_load_dwordx4 v6, s[48:51], s69 offen nt lds
L_now2:
  s_lshl_b32 s69, s3, 13
  s_lshl_b32 s70, s62, 11
  s_add_u32 s69, s69, s70
  s_add_u32 s69, s69, 65536
  s_cmp_eq_u32 s62, 3
  s_cselect_b32 s70, 0, 1024
  s_add_u32 s70, s70, s69
  s_mov_b32 s60, 60000
L_pl8:
  buffer_load_dwordx4 v[64:67], v3, s[40:43], s69 offen sc1
  buffer_load_dwordx4 v[68:71], v3, s[40:43], s70 offen sc1
L_pc10:
  s_waitcnt vmcnt(0)
  v_xor_b32 v64, s84, v64
  v_xor_b32 v65, s85, v65
  v_xor_b32 v66, s86, v66
  v_xor_b32 v67, s87, v67
  v_xor_b32 v68, s84, v68
  v_xor_b32 v69, s85, v69
  v_xor_b32 v70, s86, v70
  v_xor_b32 v71, s87, v71
  v_or3_b32 v40, v64, v65, v66
  v_or3_b32 v40, v40, v67, v68
  v_or3_b32 v40, v40, v69, v70
  v_or_b32 v40, v40, v71
  v_and_b32 v40, 1023, v40
  v_cmp_ne_u32 vcc, 0, v40
  s_cbranch_vccz L_pd9
  s_sleep 32
  s_sub_u32 s60, s60, 1
  s_cmp_lg_u32 s60, 0
  s_cbranch_scc1 L_pl8
L_pd9:
  s_nop 1
  v_lshlrev_b32 v40, 3, v1
  v_add_u32 v40, s64, v40
  s_mov_b32 s61, 0x07060302
  v_perm_b32 v36, v65, v64, s61
  v_perm_b32 v37, v67, v66, s61
  v_perm_b32 v38, v69, v68, s61
  v_perm_b32 v39, v71, v70, s61
  ds_write_b64 v40, v[36:37] offset:0
  ds_write_b64 v40, v[38:39] offset:512
  s_waitcnt lgkmcnt(0)
  s_cmp_eq_u32 s78, 0
  s_cbranch_scc1 L_gemv
  v_mov_b32 v16, 1
  v_mov_b32 v17, 0
  s_mov_b64 exec, 1
  ds_add_u32 v17, v16 offset:5120
  s_mov_b64 exec, -1
  s_branch L_gemvz
L_post:
  s_cmp_lg_u32 s3, 3
  s_cbranch_scc1 L_wof
  s_cmp_lt_u32 s67, 4
  s_cbranch_scc1 L_wof
  s_lshl_b32 s71, s31, 2
  s_add_u32 s71, s71, s67
  s_sub_u32 s71, s71, 4
  s_lshl_b32 s73, s71, 6
  s_add_u32 s73, s73, 98304
  s_mov_b32 s52, s22
  s_and_b32 s53, s23, 0xffff
  s_mov_b32 s54, 0x400
  s_mov_b32 s55, 0x20000
  v_and_b32 v7, 15, v1
  v_lshlrev_b32 v8, 1, v7
  s_and_b32 s69, s71, 31
  s_lshl_b32 s69, s69, 5
  buffer_load_ushort v44, v8, s[52:55], s69 offen
  s_lshl_b32 s75, s71, 5
  buffer_load_ushort v43, v8, s[56:59], s75 offen
  v_lshlrev_b32 v9, 9, v51
  v_lshl_add_u32 v9, v7, 2, v9
  v_mov_b32 v45, s84
  v_cmp_eq_u32 vcc, 1, v46
  v_mov_b32 v11, s85
  s_nop 0
  v_cndmask_b32 v45, v45, v11, vcc
  v_cmp_eq_u32 vcc, 2, v46
  v_mov_b32 v11, s86
  s_nop 0
  v_cndmask_b32 v45, v45, v11, vcc
  v_cmp_eq_u32 vcc, 3, v46
  v_mov_b32 v11, s87
  s_nop 0
  v_cndmask_b32 v45, v45, v11, vcc
  s_mov_b32 s60, 60000
L_pl11:
  s_sleep 127
  buffer_load_dword v64, v9, s[40:43], s73 offen sc1
L_pc13:
  s_waitcnt vmcnt(0)
  v_xor_b32 v64, v45, v64
  v_and_b32 v40, 1023, v64
  v_cmp_ne_u32 vcc, 0, v40
  s_cbranch_vccz L_pd12
  s_sub_u32 s60, s60, 1
  s_cmp_lg_u32 s60, 0
  s_cbranch_scc1 L_pl11
L_pd12:
  s_nop 1
  v_mov_b32 v40, v64
  s_nop 1
  v_permlane16_swap_b32 v64, v40
  v_add_f32 v64, v64, v40
  v_mov_b32 v40, v64
  s_nop 1
  v_permlane32_swap_b32 v64, v40
  v_add_f32 v64, v64, v40
  v_cvt_pk_bf16_f32 v40, v64, v64
  v_lshlrev_b32 v64, 16, v40
  v_lshlrev_b32 v44, 16, v44
  v_add_f32 v64, v64, v44
  v_cvt_pk_bf16_f32 v40, v64, v64
  v_lshlrev_b32 v64, 16, v40
  v_mul_f32 v40, 0xbfb8aa3b, v64
  v_exp_f32 v40, v40
  s_nop 0
  v_add_f32 v40, 1.0, v40
  v_rcp_f32 v40, v40
  s_nop 0
  v_mul_f32 v52, v64, v40
  v_cvt_pk_bf16_f32 v40, v52, v52
  v_lshlrev_b32 v52, 16, v40
  v_lshlrev_b32 v53, 16, v43
  v_lshlrev_b32 v7, 3, v7
  ds_write_b64 v7, v[52:53] offset:7168
L_wof:
  v_lshlrev_b32 v20, 7, v51
  v_lshl_add_u32 v20, v47, 8, v20
  v_lshl_add_u32 v20, v46, 3, v20
  v_lshl_add_u32 v20, v47, 5, v20
  v_and_b32 v7, 16, v1
  v_lshl_add_u32 v20, v7, 3, v20
  s_lshl_b32 s70, s3, 6
  v_xor_b32 v20, s70, v20
  v_xor_b32 v21, 32, v20
  s_mov_b32 s52, s12
  s_and_b32 s53, s13, 0xffff
  s_mov_b32 s54, 0x400000
  s_mov_b32 s55, 0x20000
  s_lshl_b32 s79, s65, 16
  s_lshl_b32 s70, s66, 8
  s_add_u32 s79, s79, s70
  s_lshl_b32 s70, s3, 14
  s_add_u32 s79, s79, s70
  s_lshl_b32 s70, s3, 12
  s_add_u32 m0, s70, 21504
  v_and_b32 v12, 15, v1
  v_lshlrev_b32 v12, 4, v12
  v_lshlrev_b32 v13, 1, v51
  v_xor_b32 v12, v12, v13
  v_lshl_add_u32 v12, v51, 6, v12
  v_xor_b32 v13, 0x80, v12
  s_lshl_b32 s76, s65, 2
  s_add_u32 s76, s76, s3
  s_lshl_b32 s76, s76, 11
  s_add_u32 s76, s76, 1048576
  v_lshlrev_b32 v4, 2, v1
  s_lshl_b32 s70, s3, 7
  v_lshl_add_u32 v6, v1, 1, s70
  v_lshl_add_u32 v8, v46, 7, v51
  s_lshl_b32 s78, s66, 6
  s_add_u32 s78, s78, s65
  s_lshl_b32 s78, s78, 9
  s_lshl_b32 s70, s3, 7
  s_add_u32 s78, s78, s70
  s_add_u32 s78, s78, 524288
  v_and_b32 v9, 4, v1
  v_lshl_add_u32 v49, v9, 4, v51
  v_lshl_add_u32 v49, v46, 17, v49
  v_and_b32 v9, 1, v1
  v_cmp_ne_u32 s[72:73], 0, v9
  v_and_b32 v9, 2, v1
  v_cmp_ne_u32 s[74:75], 0, v9
  v_and_b32 v9, 4, v1
  v_cmp_ne_u32 s[80:81], 0, v9
  v_mov_b32 v45, s84
  v_mov_b32 v11, s85
  v_cndmask_b32 v45, v45, v11, s[72:73]
  v_mov_b32 v10, s86
  v_mov_b32 v11, s87
  v_cndmask_b32 v10, v10, v11, s[72:73]
  v_cndmask_b32 v45, v45, v10, s[74:75]
  s_setprio 3
  s_waitcnt lgkmcnt(0)
  s_barrier
  buffer_load_dwordx4 v12, s[52:55], s79 offen nt lds
  s_add_u32 s79, s79, 4096
  s_add_u32 m0, m0, 1024
  s_nop 0
  buffer_load_dwordx4 v12, s[52:55], s79 offen nt lds
  s_add_u32 s79, s79, 4096
  s_add_u32 m0, m0, 1024
  s_nop 0
  buffer_load_dwordx4 v13, s[52:55], s79 offen nt lds
  s_add_u32 s79, s79, 4096
  s_add_u32 m0, m0, 1024
  s_nop 0
  buffer_load_dwordx4 v13, s[52:55], s79 offen nt lds
  s_waitcnt vmcnt(0)
  buffer_load_dword v64, v4, s[40:43], s76 offen offset:0 sc1
  buffer_load_dword v65, v4, s[40:43], s76 offen offset:256 sc1
  buffer_load_dword v66, v4, s[40:43], s76 offen offset:512 sc1
  buffer_load_dword v67, v4, s[40:43], s76 offen offset:768 sc1
  buffer_load_dword v68, v4, s[40:43], s76 offen offset:1024 sc1
  buffer_load_dword v69, v4, s[40:43], s76 offen offset:1280 sc1
  buffer_load_dword v70, v4, s[40:43], s76 offen offset:1536 sc1
  buffer_load_dword v71, v4, s[40:43], s76 offen offset:1792 sc1
  s_waitcnt vmcnt(8)
  v_mov_b32 v16, 1
  v_mov_b32 v17, 0
  s_mov_b64 exec, 1
  ds_add_u32 v17, v16 offset:5132
  s_mov_b64 exec, -1
  v_mov_b32 v17, 0
  s_mov_b32 s60, 480000
L_ll17:
  ds_read_b32 v16, v17 offset:5132
  s_waitcnt lgkmcnt(0)
  v_readfirstlane_b32 s61, v16
  s_cmp_ge_u32 s61, 4
  s_cbranch_scc1 L_lg18
  s_sub_u32 s60, s60, 1
  s_cmp_lg_u32 s60, 0
  s_cbranch_scc1 L_ll17
L_lg18:
  ds_read_b64_tr_b16 v[128:129], v20 offset:21504
  ds_read_b64_tr_b16 v[130:131], v20 offset:22528
  ds_read_b64_tr_b16 v[132:133], v20 offset:29696
  ds_read_b64_tr_b16 v[134:135], v20 offset:30720
  ds_read_b64_tr_b16 v[136:137], v21 offset:21504
  ds_read_b64_tr_b16 v[138:139], v21 offset:22528
  ds_read_b64_tr_b16 v[140:141], v21 offset:29696
  ds_read_b64_tr_b16 v[142:143], v21 offset:30720
  s_waitcnt lgkmcnt(0)
  s_mov_b32 s60, 60000
  s_branch L_pc16
L_pl14:
  buffer_load_dword v64, v4, s[40:43], s76 offen offset:0 sc1
  buffer_load_dword v65, v4, s[40:43], s76 offen offset:256 sc1
  buffer_load_dword v66, v4, s[40:43], s76 offen offset:512 sc1
  buffer_load_dword v67, v4, s[40:43], s76 offen offset:768 sc1
  buffer_load_dword v68, v4, s[40:43], s76 offen offset:1024 sc1
  buffer_load_dword v69, v4, s[40:43], s76 offen offset:1280 sc1
  buffer_load_dword v70, v4, s[40:43], s76 offen offset:1536 sc1
  buffer_load_dword v71, v4, s[40:43], s76 offen offset:1792 sc1
L_pc16:
  s_waitcnt vmcnt(0)
  v_xor_b32 v64, v45, v64
  v_xor_b32 v65, v45, v65
  v_xor_b32 v66, v45, v66
  v_xor_b32 v67, v45, v67
  v_xor_b32 v68, v45, v68
  v_xor_b32 v69, v45, v69
  v_xor_b32 v70, v45, v70
  v_xor_b32 v71, v45, v71
  v_or3_b32 v40, v64, v65, v66
  v_or3_b32 v40, v40, v67, v68
  v_or3_b32 v40, v40, v69, v70
  v_or_b32 v40, v40, v71
  v_and_b32 v40, 1023, v40
  v_cmp_ne_u32 vcc, 0, v40
  s_cbranch_vccz L_pd15
  s_sleep 1
  s_sub_u32 s60, s60, 1
  s_cmp_lg_u32 s60, 0
  s_cbranch_scc1 L_pl14
L_pd15:
  s_nop 1
  v_and_b32 v72, 0x400, v64
  v_and_b32 v73, 0x400, v65
  v_and_b32 v74, 0x400, v66
  v_and_b32 v75, 0x400, v67
  v_and_b32 v76, 0x400, v68
  v_and_b32 v77, 0x400, v69
  v_and_b32 v78, 0x400, v70
  v_and_b32 v79, 0x400, v71
  v_cmp_ne_u32 s[32:33], 0, v72
  v_cmp_ne_u32 s[34:35], 0, v73
  v_cmp_ne_u32 s[36:37], 0, v74
  v_cmp_ne_u32 s[38:39], 0, v75
  v_cmp_ne_u32 s[48:49], 0, v76
  v_cmp_ne_u32 s[50:51], 0, v77
  v_cmp_ne_u32 s[52:53], 0, v78
  v_cmp_ne_u32 s[54:55], 0, v79
  v_xor_b32 v64, v64, v72
  v_xor_b32 v65, v65, v73
  v_xor_b32 v66, v66, v74
  v_xor_b32 v67, v67, v75
  v_xor_b32 v68, v68, v76
  v_xor_b32 v69, v69, v77
  v_xor_b32 v70, v70, v78
  v_xor_b32 v71, v71, v79
  v_mov_b32 v80, s32
  v_mov_b32 v81, s34
  v_max_f32 v80, s36, v80
  v_max_f32 v81, s38, v81
  v_max_f32 v80, s48, v80
  v_max_f32 v81, s50, v81
  v_max_f32 v80, s52, v80
  v_max_f32 v81, s54, v81
  v_max_f32 v80, v80, v81
  v_sub_f32 v72, s32, v80
  v_sub_f32 v73, s34, v80
  v_sub_f32 v74, s36, v80
  v_sub_f32 v75, s38, v80
  v_sub_f32 v76, s48, v80
  v_sub_f32 v77, s50, v80
  v_sub_f32 v78, s52, v80
  v_sub_f32 v79, s54, v80
  v_exp_f32 v72, v72
  v_exp_f32 v73, v73
  v_exp_f32 v74, v74
  v_exp_f32 v75, v75
  v_exp_f32 v76, v76
  v_exp_f32 v77, v77
  v_exp_f32 v78, v78
  v_exp_f32 v79, v79
  v_mul_f32 v82, s33, v72
  v_mul_f32 v83, v64, v72
  v_fmac_f32 v82, s35, v73
  v_fmac_f32 v83, v65, v73
  v_fmac_f32 v82, s37, v74
  v_fmac_f32 v83, v66, v74
  v_fmac_f32 v82, s39, v75
  v_fmac_f32 v83, v67, v75
  v_fmac_f32 v82, s49, v76
  v_fmac_f32 v83, v68, v76
  v_fmac_f32 v82, s51, v77
  v_fmac_f32 v83, v69, v77
  v_fmac_f32 v82, s53, v78
  v_fmac_f32 v83, v70, v78
  v_fmac_f32 v82, s55, v79
  v_fmac_f32 v83, v71, v79
  v_rcp_f32 v82, v82
  s_nop 0
  v_mul_f32 v83, v83, v82
  v_cvt_pk_bf16_f32 v83, v83, v83
  ds_write_b16 v6, v83 offset:6144
  v_mov_b32 v16, 1
  v_mov_b32 v17, 0
  s_mov_b64 exec, 1
  ds_add_u32 v17, v16 offset:5140
  s_mov_b64 exec, -1
  v_mov_b32 v17, 0
  s_mov_b32 s60, 480000
L_ll19:
  ds_read_b32 v16, v17 offset:5140
  s_waitcnt lgkmcnt(0)
  v_readfirstlane_b32 s61, v16
  s_cmp_ge_u32 s61, 4
  s_cbranch_scc1 L_lg20
  s_sub_u32 s60, s60, 1
  s_cmp_lg_u32 s60, 0
  s_cbranch_scc1 L_ll19
L_lg20:
  ds_read_b128 v[84:87], v8 offset:6144
  ds_read_b128 v[88:91], v8 offset:6208
  s_waitcnt lgkmcnt(1)
  v_mfma_f32_16x16x32_bf16 v[96:99], v[128:131], v[84:87], 0
  v_mfma_f32_16x16x32_bf16 v[100:103], v[136:139], v[84:87], 0
  s_waitcnt lgkmcnt(0)
  v_mfma_f32_16x16x32_bf16 v[96:99], v[132:135], v[88:91], v[96:99]
  v_mfma_f32_16x16x32_bf16 v[100:103], v[140:143], v[88:91], v[100:103]
  s_nop 7
  v_cndmask_b32 v96, v96, v100, s[80:81]
  v_cndmask_b32 v97, v97, v101, s[80:81]
  v_cndmask_b32 v98, v98, v102, s[80:81]
  v_cndmask_b32 v99, v99, v103, s[80:81]
  v_add_u32 v96, 512, v96
  v_add_u32 v97, 512, v97
  v_add_u32 v98, 512, v98
  v_add_u32 v99, 512, v99
  v_and_or_b32 v96, v96, v61, s84
  v_and_or_b32 v97, v97, v61, s85
  v_and_or_b32 v98, v98, v61, s86
  v_and_or_b32 v99, v99, v61, s87
  s_mov_b32 exec_lo, 0x00ff00ff
  s_mov_b32 exec_hi, 0x00ff00ff
  buffer_store_dwordx4 v[96:99], v49, s[40:43], s78 offen sc1
  s_mov_b64 exec, -1
  s_branch L_fin
L_stream:
  s_cmp_lg_u32 s3, 4
  s_cbranch_scc1 L_nocpf
  s_getpc_b64 s[52:53]
L_pc:
  s_sub_u32 s52, s52, L_pc-recurrent_scan__gqa_block_cached__dense_activation_squared_relu__decode_kernel
  s_subb_u32 s53, s53, 0
  s_and_b32 s53, s53, 0xffff
  s_mov_b32 s54, L_codeend-recurrent_scan__gqa_block_cached__dense_activation_squared_relu__decode_kernel
  s_mov_b32 s55, 0x20000
  s_and_b32 s69, s31, 15
  s_lshl_b32 s69, s69, 10
  buffer_load_dwordx4 v[20:23], v3, s[52:55], s69 offen
L_nocpf:
  v_lshrrev_b32 v4, 4, v1
  v_lshlrev_b32 v4, 6, v4
  v_bfe_u32 v5, v1, 2, 2
  v_lshlrev_b32 v5, 8, v5
  v_and_b32 v6, 3, v1
  v_lshlrev_b32 v7, 4, v6
  v_add3_u32 v2, v4, v5, v7
  s_sub_u32 s64, s3, 4
  s_lshl_b32 s72, s31, 22
  s_cmp_lt_u32 s67, 4
  s_cselect_b32 s83, 28, 30
  s_cselect_b32 s82, 0, 0
  s_lshr_b32 s81, s67, 2
  s_lshl_b32 s81, s81, 21
  s_add_u32 s81, s81, s72
  s_and_b32 s66, s67, 3
  s_lshl_b32 s66, s66, 14
  s_add_u32 s81, s81, s66
  s_lshl_b32 s66, s64, 12
  s_add_u32 s81, s81, s66
  s_mul_i32 s94, s31, 4
  s_sub_u32 s65, s94, s83
  s_and_b32 s65, s65, 31
  s_lshl_b32 s65, s65, 16
  s_add_u32 s95, s81, s65
  s_mov_b32 s68, s72
  s_waitcnt lgkmcnt(0)
  s_mov_b32 s32, s6
  s_and_b32 s33, s7, 0xffff
  s_mov_b32 s34, 0x8000000
  s_mov_b32 s35, 0x20000
  s_mov_b32 s36, s8
  s_and_b32 s37, s9, 0xffff
  s_mov_b32 s38, 0x8000000
  s_mov_b32 s39, 0x20000
  s_cmp_ge_u32 s67, 3
  s_cbranch_scc1 L_nobi
  s_barrier
L_nobi:
  s_add_u32 s79, s94, 31
  s_and_b32 s79, s79, 31
  s_lshl_b32 s79, s79, 16
  s_add_u32 s78, s81, s65
  s_cmp_eq_u32 s82, 0
  s_cselect_b32 s34, s34, 0
  s_cselect_b64 s[56:57], 0, -1
  buffer_load_dwordx4 v[64:67], v2, s[32:35], s78 offen offset:0 nt
  buffer_load_dwordx4 v[68:71], v2, s[32:35], s78 offen offset:1024 nt
  buffer_load_dwordx4 v[72:75], v2, s[32:35], s78 offen offset:2048 nt
  buffer_load_dwordx4 v[76:79], v2, s[32:35], s78 offen offset:3072 nt
  s_mov_b32 s34, 0x8000000
  s_cmp_lt_u32 s67, 3
  s_cbranch_scc1 L_nobi2
  s_barrier
L_nobi2:
  s_add_u32 s65, s65, 65536
  s_and_b32 s65, s65, 2031616
  s_add_u32 s78, s81, s65
  buffer_load_dwordx4 v[80:83], v2, s[32:35], s78 offen offset:0 nt
  buffer_load_dwordx4 v[84:87], v2, s[32:35], s78 offen offset:1024 nt
  s_waitcnt vmcnt(5)
  buffer_load_dwordx4 v[88:91], v2, s[32:35], s78 offen offset:2048 nt
  s_waitcnt vmcnt(5)
  buffer_load_dwordx4 v[92:95], v2, s[32:35], s78 offen offset:3072 nt
  s_add_u32 s65, s65, 65536
  s_and_b32 s65, s65, 2031616
  s_add_u32 s78, s81, s65
  s_waitcnt vmcnt(5)
  buffer_load_dwordx4 v[96:99], v2, s[32:35], s78 offen offset:0 nt
  s_waitcnt vmcnt(5)
  buffer_load_dwordx4 v[100:103], v2, s[32:35], s78 offen offset:1024 nt
  s_waitcnt vmcnt(5)
  buffer_load_dwordx4 v[104:107], v2, s[32:35], s78 offen offset:2048 nt
  s_waitcnt vmcnt(5)
  buffer_load_dwordx4 v[108:111], v2, s[32:35], s78 offen offset:3072 nt
  s_add_u32 s65, s65, 65536
  s_and_b32 s65, s65, 2031616
  s_add_u32 s78, s81, s65
  s_waitcnt vmcnt(5)
  buffer_load_dwordx4 v[112:115], v2, s[32:35], s78 offen offset:0 nt
  s_waitcnt vmcnt(5)
  buffer_load_dwordx4 v[116:119], v2, s[32:35], s78 offen offset:1024 nt
  s_waitcnt vmcnt(5)
  buffer_load_dwordx4 v[120:123], v2, s[32:35], s78 offen offset:2048 nt
  s_waitcnt vmcnt(5)
  buffer_load_dwordx4 v[124:127], v2, s[32:35], s78 offen offset:3072 nt
  s_add_u32 s65, s65, 65536
  s_and_b32 s65, s65, 2031616
  s_add_u32 s78, s81, s65
  s_waitcnt vmcnt(5)
  buffer_load_dwordx4 v[128:131], v2, s[32:35], s78 offen offset:0 nt
  s_waitcnt vmcnt(5)
  buffer_load_dwordx4 v[132:135], v2, s[32:35], s78 offen offset:1024 nt
  s_waitcnt vmcnt(5)
  buffer_load_dwordx4 v[136:139], v2, s[32:35], s78 offen offset:2048 nt
  s_waitcnt vmcnt(5)
  buffer_load_dwordx4 v[140:143], v2, s[32:35], s78 offen offset:3072 nt
  s_add_u32 s65, s65, 65536
  s_and_b32 s65, s65, 2031616
  s_add_u32 s78, s81, s65
  s_waitcnt vmcnt(5)
  buffer_load_dwordx4 v[144:147], v2, s[32:35], s78 offen offset:0 nt
  s_waitcnt vmcnt(5)
  buffer_load_dwordx4 v[148:151], v2, s[32:35], s78 offen offset:1024 nt
  s_waitcnt vmcnt(5)
  buffer_load_dwordx4 v[152:155], v2, s[32:35], s78 offen offset:2048 nt
  s_waitcnt vmcnt(5)
  buffer_load_dwordx4 v[156:159], v2, s[32:35], s78 offen offset:3072 nt
  s_add_u32 s65, s65, 65536
  s_and_b32 s65, s65, 2031616
  s_add_u32 s78, s81, s65
  s_waitcnt vmcnt(5)
  buffer_load_dwordx4 v[160:163], v2, s[32:35], s78 offen offset:0 nt
  s_waitcnt vmcnt(5)
  buffer_load_dwordx4 v[164:167], v2, s[32:35], s78 offen offset:1024 nt
  s_waitcnt vmcnt(5)
  buffer_load_dwordx4 v[168:171], v2, s[32:35], s78 offen offset:2048 nt
  s_waitcnt vmcnt(5)
  buffer_load_dwordx4 v[172:175], v2, s[32:35], s78 offen offset:3072 nt
  s_add_u32 s65, s65, 65536
  s_and_b32 s65, s65, 2031616
  s_add_u32 s78, s81, s65
  s_waitcnt vmcnt(5)
  buffer_load_dwordx4 v[176:179], v2, s[32:35], s78 offen offset:0 nt
  s_waitcnt vmcnt(5)
  buffer_load_dwordx4 v[180:183], v2, s[32:35], s78 offen offset:1024 nt
  s_waitcnt vmcnt(5)
  buffer_load_dwordx4 v[184:187], v2, s[32:35], s78 offen offset:2048 nt
  s_waitcnt vmcnt(5)
  buffer_load_dwordx4 v[188:191], v2, s[32:35], s78 offen offset:3072 nt
  s_add_u32 s65, s65, 65536
  s_and_b32 s65, s65, 2031616
  s_add_u32 s78, s81, s65
  s_waitcnt vmcnt(5)
  buffer_load_dwordx4 v[192:195], v2, s[32:35], s78 offen offset:0 nt
  s_waitcnt vmcnt(5)
  buffer_load_dwordx4 v[196:199], v2, s[32:35], s78 offen offset:1024 nt
  s_waitcnt vmcnt(5)
  buffer_load_dwordx4 v[200:203], v2, s[32:35], s78 offen offset:2048 nt
  s_waitcnt vmcnt(5)
  buffer_load_dwordx4 v[204:207], v2, s[32:35], s78 offen offset:3072 nt
  s_add_u32 s65, s65, 65536
  s_and_b32 s65, s65, 2031616
  s_add_u32 s78, s81, s65
  s_waitcnt vmcnt(5)
  buffer_load_dwordx4 v[208:211], v2, s[32:35], s78 offen offset:0 nt
  s_waitcnt vmcnt(5)
  buffer_load_dwordx4 v[212:215], v2, s[32:35], s78 offen offset:1024 nt
  s_waitcnt vmcnt(5)
  buffer_load_dwordx4 v[216:219], v2, s[32:35], s78 offen offset:2048 nt
  s_waitcnt vmcnt(5)
  buffer_load_dwordx4 v[220:223], v2, s[32:35], s78 offen offset:3072 nt
  s_add_u32 s65, s65, 65536
  s_and_b32 s65, s65, 2031616
  s_add_u32 s78, s81, s65
  s_waitcnt vmcnt(5)
  buffer_load_dwordx4 v[224:227], v2, s[32:35], s78 offen offset:0 nt
  s_waitcnt vmcnt(5)
  buffer_load_dwordx4 v[228:231], v2, s[32:35], s78 offen offset:1024 nt
  s_waitcnt vmcnt(5)
  buffer_load_dwordx4 v[232:235], v2, s[32:35], s78 offen offset:2048 nt
  s_waitcnt vmcnt(5)
  buffer_load_dwordx4 v[236:239], v2, s[32:35], s78 offen offset:3072 nt
  s_add_u32 s65, s65, 65536
  s_and_b32 s65, s65, 2031616
  s_add_u32 s78, s81, s65
  s_waitcnt vmcnt(5)
  buffer_load_dwordx4 v[240:243], v2, s[32:35], s78 offen offset:0 nt
  s_waitcnt vmcnt(5)
  buffer_load_dwordx4 v[244:247], v2, s[32:35], s78 offen offset:1024 nt
  s_waitcnt vmcnt(5)
  buffer_load_dwordx4 v[248:251], v2, s[32:35], s78 offen offset:2048 nt
  s_waitcnt vmcnt(5)
  buffer_load_dwordx4 v[252:255], v2, s[32:35], s78 offen offset:3072 nt
  s_add_u32 s65, s65, 65536
  s_and_b32 s65, s65, 2031616
  s_mov_b32 s40, s28
  s_and_b32 s41, s29, 0xffff
  s_mov_b32 s42, 0x20000000
  s_mov_b32 s43, 0x20000
  v_and_b32 v8, 1, v1
  v_lshlrev_b32 v8, 4, v8
  v_mov_b32 v9, 0xffff
  v_lshlrev_b32 v8, v8, v9
  v_cmp_gt_u32 vcc, 2, v6
  s_nop 1
  v_cndmask_b32 v4, 0, v8, vcc
  v_sub_u32 v5, v8, v4
  s_mov_b32 s70, 0x3db504f3
  s_mov_b32 s71, 0x3fb8aa3b
  s_lshl_b32 s72, s31, 8
  s_add_u32 s72, s72, 131072
  s_add_u32 s76, s28, s72
  s_addc_u32 s77, s29, 0
  v_mov_b32 v10, 0
  v_mov_b32 v11, 0
  v_mov_b32 v12, 0
  v_mov_b32 v13, 0
  v_mov_b32 v14, 0
  v_mov_b32 v15, 0
  v_mov_b32 v16, 0
  v_mov_b32 v17, 0
  v_mov_b32 v18, 0xff61b1e6
  v_mov_b32 v19, 0
  v_cmp_eq_u32 s[44:45], 1, v6
  v_cmp_eq_u32 s[46:47], 2, v6
  v_cmp_eq_u32 s[48:49], 3, v6
  v_bfe_u32 v40, v1, 2, 2
  v_mul_u32_u24 v56, 528, v40
  v_lshrrev_b32 v42, 4, v1
  v_lshlrev_b32 v42, 7, v42
  v_lshlrev_b32 v43, 2, v6
  v_add3_u32 v56, v56, v42, v43
  s_mul_i32 s73, s64, 2112
  v_add_u32 v56, s73, v56
  v_lshlrev_b32 v57, 3, v40
  s_lshl_b32 s73, s64, 5
  v_add_u32 v57, s73, v57
  v_and_b32 v46, 31, v1
  v_lshlrev_b32 v46, 4, v46
  s_mul_i32 s73, s64, 528
  v_add_u32 v46, s73, v46
  v_bfe_u32 v47, v1, 4, 1
  v_lshlrev_b32 v47, 13, v47
  v_and_b32 v42, 15, v1
  v_lshl_add_u32 v47, v42, 4, v47
  v_and_b32 v41, 7, v1
  v_lshlrev_b32 v41, 2, v41
  v_and_b32 v42, 8, v1
  v_cmp_ne_u32 s[50:51], 0, v42
  s_lshl_b32 s58, s63, 2
  s_add_u32 s58, s58, s64
  s_lshl_b32 s58, s58, 6
  s_lshl_b32 s73, s62, 3
  s_add_u32 s58, s58, s73
  s_add_u32 s58, s58, s67
  s_lshl_b32 s58, s58, 8
  s_add_u32 s58, s58, 1048576
  s_barrier
  ds_read_b128 v[6:9], v2 offset:4096
  v_mov_b32 v60, 0
  ds_read_b64 v[58:59], v60 offset:5152
  s_waitcnt lgkmcnt(0)
  v_mov_b32 v61, 0xfffffc00
  v_readfirstlane_b32 s86, v58
  v_readfirstlane_b32 s87, v59
  s_lshr_b32 s84, s86, 22
  s_bfe_u32 s85, s86, 655372
  s_bfe_u32 s86, s86, 655362
  s_and_b32 s87, s87, 1023
  s_mul_i32 s66, s64, 8448
  s_add_u32 s66, s66, 103424
  v_lshl_add_u32 v58, v1, 2, s66
  v_mov_b32 v59, v58
  s_waitcnt vmcnt(44)
  v_mfma_f32_16x16x32_bf16 v[20:23], v[64:67], v[6:9], 0
  v_mfma_f32_16x16x32_bf16 v[24:27], v[68:71], v[6:9], 0
  v_mfma_f32_16x16x32_bf16 v[28:31], v[72:75], v[6:9], 0
  v_mfma_f32_16x16x32_bf16 v[32:35], v[76:79], v[6:9], 0
  s_add_u32 s78, s81, s65
  buffer_load_dwordx4 v[64:67], v2, s[32:35], s78 offen offset:0 nt
  buffer_load_dwordx4 v[68:71], v2, s[32:35], s78 offen offset:1024 nt
  buffer_load_dwordx4 v[72:75], v2, s[32:35], s78 offen offset:2048 nt
  buffer_load_dwordx4 v[76:79], v2, s[32:35], s78 offen offset:3072 nt
  s_add_u32 s65, s65, 65536
  s_and_b32 s65, s65, 2031616
  v_cndmask_b32 v36, v20, v25, s[44:45]
  v_cndmask_b32 v37, v24, v21, s[44:45]
  v_cndmask_b32 v38, v28, v33, s[44:45]
  v_cndmask_b32 v39, v32, v29, s[44:45]
  v_cndmask_b32 v36, v36, v30, s[46:47]
  v_cndmask_b32 v37, v37, v34, s[46:47]
  v_cndmask_b32 v38, v38, v22, s[46:47]
  v_cndmask_b32 v39, v39, v26, s[46:47]
  v_cndmask_b32 v37, v37, v31, s[48:49]
  v_cndmask_b32 v38, v38, v27, s[48:49]
  v_cndmask_b32 v39, v39, v23, s[48:49]
  v_cndmask_b32 v36, v36, v35, s[48:49]
  v_add_f32_dpp v36, v37, v36 quad_perm:[1,0,3,2] row_mask:0xf bank_mask:0xf
  v_add_f32_dpp v36, v38, v36 quad_perm:[2,3,0,1] row_mask:0xf bank_mask:0xf
  v_add_f32_dpp v36, v39, v36 quad_perm:[3,2,1,0] row_mask:0xf bank_mask:0xf
  v_cvt_pk_bf16_f32 v40, v36, v36
  v_lshlrev_b32 v36, 16, v40
  v_mul_f32 v36, s70, v36
  v_cvt_pk_bf16_f32 v40, v36, v36
  v_lshlrev_b32 v36, 16, v40
  v_mul_f32 v36, s71, v36
  v_cndmask_b32 v36, v36, v18, s[56:57]
  s_lshl_b32 s73, s83, 8
  v_add_u32 v59, s73, v58
  ds_write_b32 v59, v36
  v_max_f32 v18, v18, v36
  s_waitcnt vmcnt(44)
  v_mfma_f32_16x16x32_bf16 v[20:23], v[80:83], v[6:9], 0
  v_mfma_f32_16x16x32_bf16 v[24:27], v[84:87], v[6:9], 0
  v_mfma_f32_16x16x32_bf16 v[28:31], v[88:91], v[6:9], 0
  v_mfma_f32_16x16x32_bf16 v[32:35], v[92:95], v[6:9], 0
  s_add_u32 s78, s81, s65
  buffer_load_dwordx4 v[80:83], v2, s[32:35], s78 offen offset:0 nt
  buffer_load_dwordx4 v[84:87], v2, s[32:35], s78 offen offset:1024 nt
  buffer_load_dwordx4 v[88:91], v2, s[32:35], s78 offen offset:2048 nt
  buffer_load_dwordx4 v[92:95], v2, s[32:35], s78 offen offset:3072 nt
  s_add_u32 s65, s65, 65536
  s_and_b32 s65, s65, 2031616
  v_cndmask_b32 v36, v20, v25, s[44:45]
  v_cndmask_b32 v37, v24, v21, s[44:45]
  v_cndmask_b32 v38, v28, v33, s[44:45]
  v_cndmask_b32 v39, v32, v29, s[44:45]
  v_cndmask_b32 v36, v36, v30, s[46:47]
  v_cndmask_b32 v37, v37, v34, s[46:47]
  v_cndmask_b32 v38, v38, v22, s[46:47]
  v_cndmask_b32 v39, v39, v26, s[46:47]
  v_cndmask_b32 v37, v37, v31, s[48:49]
  v_cndmask_b32 v38, v38, v27, s[48:49]
  v_cndmask_b32 v39, v39, v23, s[48:49]
  v_cndmask_b32 v36, v36, v35, s[48:49]
  v_add_f32_dpp v36, v37, v36 quad_perm:[1,0,3,2] row_mask:0xf bank_mask:0xf
  v_add_f32_dpp v36, v38, v36 quad_perm:[2,3,0,1] row_mask:0xf bank_mask:0xf
  v_add_f32_dpp v36, v39, v36 quad_perm:[3,2,1,0] row_mask:0xf bank_mask:0xf
  v_cvt_pk_bf16_f32 v40, v36, v36
  v_lshlrev_b32 v36, 16, v40
  v_mul_f32 v36, s70, v36
  v_cvt_pk_bf16_f32 v40, v36, v36
  v_lshlrev_b32 v36, 16, v40
  v_mul_f32 v36, s71, v36
  ds_write_b32 v58, v36 offset:256
  v_max_f32 v18, v18, v36
  s_waitcnt vmcnt(44)
  v_mfma_f32_16x16x32_bf16 v[20:23], v[96:99], v[6:9], 0
  v_mfma_f32_16x16x32_bf16 v[24:27], v[100:103], v[6:9], 0
  v_mfma_f32_16x16x32_bf16 v[28:31], v[104:107], v[6:9], 0
  v_mfma_f32_16x16x32_bf16 v[32:35], v[108:111], v[6:9], 0
  s_nop 5
  v_cndmask_b32 v36, v20, v25, s[44:45]
  v_cndmask_b32 v37, v24, v21, s[44:45]
  v_cndmask_b32 v38, v28, v33, s[44:45]
  v_cndmask_b32 v39, v32, v29, s[44:45]
  v_cndmask_b32 v36, v36, v30, s[46:47]
  v_cndmask_b32 v37, v37, v34, s[46:47]
  v_cndmask_b32 v38, v38, v22, s[46:47]
  v_cndmask_b32 v39, v39, v26, s[46:47]
  v_cndmask_b32 v37, v37, v31, s[48:49]
  v_cndmask_b32 v38, v38, v27, s[48:49]
  v_cndmask_b32 v39, v39, v23, s[48:49]
  v_cndmask_b32 v36, v36, v35, s[48:49]
  v_add_f32_dpp v36, v37, v36 quad_perm:[1,0,3,2] row_mask:0xf bank_mask:0xf
  v_add_f32_dpp v36, v38, v36 quad_perm:[2,3,0,1] row_mask:0xf bank_mask:0xf
  v_add_f32_dpp v36, v39, v36 quad_perm:[3,2,1,0] row_mask:0xf bank_mask:0xf
  v_cvt_pk_bf16_f32 v40, v36, v36
  v_lshlrev_b32 v36, 16, v40
  v_mul_f32 v36, s70, v36
  v_cvt_pk_bf16_f32 v40, v36, v36
  v_lshlrev_b32 v36, 16, v40
  v_mul_f32 v36, s71, v36
  ds_write_b32 v58, v36 offset:512
  v_max_f32 v18, v18, v36
  s_waitcnt vmcnt(40)
  v_mfma_f32_16x16x32_bf16 v[20:23], v[112:115], v[6:9], 0
  v_mfma_f32_16x16x32_bf16 v[24:27], v[116:119], v[6:9], 0
  v_mfma_f32_16x16x32_bf16 v[28:31], v[120:123], v[6:9], 0
  v_mfma_f32_16x16x32_bf16 v[32:35], v[124:127], v[6:9], 0
  s_nop 5
  v_cndmask_b32 v36, v20, v25, s[44:45]
  v_cndmask_b32 v37, v24, v21, s[44:45]
  v_cndmask_b32 v38, v28, v33, s[44:45]
  v_cndmask_b32 v39, v32, v29, s[44:45]
  v_cndmask_b32 v36, v36, v30, s[46:47]
  v_cndmask_b32 v37, v37, v34, s[46:47]
  v_cndmask_b32 v38, v38, v22, s[46:47]
  v_cndmask_b32 v39, v39, v26, s[46:47]
  v_cndmask_b32 v37, v37, v31, s[48:49]
  v_cndmask_b32 v38, v38, v27, s[48:49]
  v_cndmask_b32 v39, v39, v23, s[48:49]
  v_cndmask_b32 v36, v36, v35, s[48:49]
  v_add_f32_dpp v36, v37, v36 quad_perm:[1,0,3,2] row_mask:0xf bank_mask:0xf
  v_add_f32_dpp v36, v38, v36 quad_perm:[2,3,0,1] row_mask:0xf bank_mask:0xf
  v_add_f32_dpp v36, v39, v36 quad_perm:[3,2,1,0] row_mask:0xf bank_mask:0xf
  v_cvt_pk_bf16_f32 v40, v36, v36
  v_lshlrev_b32 v36, 16, v40
  v_mul_f32 v36, s70, v36
  v_cvt_pk_bf16_f32 v40, v36, v36
  v_lshlrev_b32 v36, 16, v40
  v_mul_f32 v36, s71, v36
  ds_write_b32 v58, v36 offset:768
  v_max_f32 v18, v18, v36
  s_waitcnt vmcnt(36)
  v_mfma_f32_16x16x32_bf16 v[20:23], v[128:131], v[6:9], 0
  v_mfma_f32_16x16x32_bf16 v[24:27], v[132:135], v[6:9], 0
  v_mfma_f32_16x16x32_bf16 v[28:31], v[136:139], v[6:9], 0
  v_mfma_f32_16x16x32_bf16 v[32:35], v[140:143], v[6:9], 0
  s_nop 5
  v_cndmask_b32 v36, v20, v25, s[44:45]
  v_cndmask_b32 v37, v24, v21, s[44:45]
  v_cndmask_b32 v38, v28, v33, s[44:45]
  v_cndmask_b32 v39, v32, v29, s[44:45]
  v_cndmask_b32 v36, v36, v30, s[46:47]
  v_cndmask_b32 v37, v37, v34, s[46:47]
  v_cndmask_b32 v38, v38, v22, s[46:47]
  v_cndmask_b32 v39, v39, v26, s[46:47]
  v_cndmask_b32 v37, v37, v31, s[48:49]
  v_cndmask_b32 v38, v38, v27, s[48:49]
  v_cndmask_b32 v39, v39, v23, s[48:49]
  v_cndmask_b32 v36, v36, v35, s[48:49]
  v_add_f32_dpp v36, v37, v36 quad_perm:[1,0,3,2] row_mask:0xf bank_mask:0xf
  v_add_f32_dpp v36, v38, v36 quad_perm:[2,3,0,1] row_mask:0xf bank_mask:0xf
  v_add_f32_dpp v36, v39, v36 quad_perm:[3,2,1,0] row_mask:0xf bank_mask:0xf
  v_cvt_pk_bf16_f32 v40, v36, v36
  v_lshlrev_b32 v36, 16, v40
  v_mul_f32 v36, s70, v36
  v_cvt_pk_bf16_f32 v40, v36, v36
  v_lshlrev_b32 v36, 16, v40
  v_mul_f32 v36, s71, v36
  ds_write_b32 v58, v36 offset:1024
  v_max_f32 v18, v18, v36
  s_waitcnt vmcnt(32)
  v_mfma_f32_16x16x32_bf16 v[20:23], v[144:147], v[6:9], 0
  v_mfma_f32_16x16x32_bf16 v[24:27], v[148:151], v[6:9], 0
  v_mfma_f32_16x16x32_bf16 v[28:31], v[152:155], v[6:9], 0
  v_mfma_f32_16x16x32_bf16 v[32:35], v[156:159], v[6:9], 0
  s_nop 5
  v_cndmask_b32 v36, v20, v25, s[44:45]
  v_cndmask_b32 v37, v24, v21, s[44:45]
  v_cndmask_b32 v38, v28, v33, s[44:45]
  v_cndmask_b32 v39, v32, v29, s[44:45]
  v_cndmask_b32 v36, v36, v30, s[46:47]
  v_cndmask_b32 v37, v37, v34, s[46:47]
  v_cndmask_b32 v38, v38, v22, s[46:47]
  v_cndmask_b32 v39, v39, v26, s[46:47]
  v_cndmask_b32 v37, v37, v31, s[48:49]
  v_cndmask_b32 v38, v38, v27, s[48:49]
  v_cndmask_b32 v39, v39, v23, s[48:49]
  v_cndmask_b32 v36, v36, v35, s[48:49]
  v_add_f32_dpp v36, v37, v36 quad_perm:[1,0,3,2] row_mask:0xf bank_mask:0xf
  v_add_f32_dpp v36, v38, v36 quad_perm:[2,3,0,1] row_mask:0xf bank_mask:0xf
  v_add_f32_dpp v36, v39, v36 quad_perm:[3,2,1,0] row_mask:0xf bank_mask:0xf
  v_cvt_pk_bf16_f32 v40, v36, v36
  v_lshlrev_b32 v36, 16, v40
  v_mul_f32 v36, s70, v36
  v_cvt_pk_bf16_f32 v40, v36, v36
  v_lshlrev_b32 v36, 16, v40
  v_mul_f32 v36, s71, v36
  ds_write_b32 v58, v36 offset:1280
  v_max_f32 v18, v18, v36
  s_waitcnt vmcnt(28)
  v_mfma_f32_16x16x32_bf16 v[20:23], v[160:163], v[6:9], 0
  v_mfma_f32_16x16x32_bf16 v[24:27], v[164:167], v[6:9], 0
  v_mfma_f32_16x16x32_bf16 v[28:31], v[168:171], v[6:9], 0
  v_mfma_f32_16x16x32_bf16 v[32:35], v[172:175], v[6:9], 0
  s_nop 5
  v_cndmask_b32 v36, v20, v25, s[44:45]
  v_cndmask_b32 v37, v24, v21, s[44:45]
  v_cndmask_b32 v38, v28, v33, s[44:45]
  v_cndmask_b32 v39, v32, v29, s[44:45]
  v_cndmask_b32 v36, v36, v30, s[46:47]
  v_cndmask_b32 v37, v37, v34, s[46:47]
  v_cndmask_b32 v38, v38, v22, s[46:47]
  v_cndmask_b32 v39, v39, v26, s[46:47]
  v_cndmask_b32 v37, v37, v31, s[48:49]
  v_cndmask_b32 v38, v38, v27, s[48:49]
  v_cndmask_b32 v39, v39, v23, s[48:49]
  v_cndmask_b32 v36, v36, v35, s[48:49]
  v_add_f32_dpp v36, v37, v36 quad_perm:[1,0,3,2] row_mask:0xf bank_mask:0xf
  v_add_f32_dpp v36, v38, v36 quad_perm:[2,3,0,1] row_mask:0xf bank_mask:0xf
  v_add_f32_dpp v36, v39, v36 quad_perm:[3,2,1,0] row_mask:0xf bank_mask:0xf
  v_cvt_pk_bf16_f32 v40, v36, v36
  v_lshlrev_b32 v36, 16, v40
  v_mul_f32 v36, s70, v36
  v_cvt_pk_bf16_f32 v40, v36, v36
  v_lshlrev_b32 v36, 16, v40
  v_mul_f32 v36, s71, v36
  ds_write_b32 v58, v36 offset:1536
  v_max_f32 v18, v18, v36
  s_waitcnt vmcnt(24)
  v_mfma_f32_16x16x32_bf16 v[20:23], v[176:179], v[6:9], 0
  v_mfma_f32_16x16x32_bf16 v[24:27], v[180:183], v[6:9], 0
  v_mfma_f32_16x16x32_bf16 v[28:31], v[184:187], v[6:9], 0
  v_mfma_f32_16x16x32_bf16 v[32:35], v[188:191], v[6:9], 0
  s_nop 5
  v_cndmask_b32 v36, v20, v25, s[44:45]
  v_cndmask_b32 v37, v24, v21, s[44:45]
  v_cndmask_b32 v38, v28, v33, s[44:45]
  v_cndmask_b32 v39, v32, v29, s[44:45]
  v_cndmask_b32 v36, v36, v30, s[46:47]
  v_cndmask_b32 v37, v37, v34, s[46:47]
  v_cndmask_b32 v38, v38, v22, s[46:47]
  v_cndmask_b32 v39, v39, v26, s[46:47]
  v_cndmask_b32 v37, v37, v31, s[48:49]
  v_cndmask_b32 v38, v38, v27, s[48:49]
  v_cndmask_b32 v39, v39, v23, s[48:49]
  v_cndmask_b32 v36, v36, v35, s[48:49]
  v_add_f32_dpp v36, v37, v36 quad_perm:[1,0,3,2] row_mask:0xf bank_mask:0xf
  v_add_f32_dpp v36, v38, v36 quad_perm:[2,3,0,1] row_mask:0xf bank_mask:0xf
  v_add_f32_dpp v36, v39, v36 quad_perm:[3,2,1,0] row_mask:0xf bank_mask:0xf
  v_cvt_pk_bf16_f32 v40, v36, v36
  v_lshlrev_b32 v36, 16, v40
  v_mul_f32 v36, s70, v36
  v_cvt_pk_bf16_f32 v40, v36, v36
  v_lshlrev_b32 v36, 16, v40
  v_mul_f32 v36, s71, v36
  ds_write_b32 v58, v36 offset:1792
  v_max_f32 v18, v18, v36
  s_waitcnt vmcnt(20)
  v_mfma_f32_16x16x32_bf16 v[20:23], v[192:195], v[6:9], 0
  v_mfma_f32_16x16x32_bf16 v[24:27], v[196:199], v[6:9], 0
  v_mfma_f32_16x16x32_bf16 v[28:31], v[200:203], v[6:9], 0
  v_mfma_f32_16x16x32_bf16 v[32:35], v[204:207], v[6:9], 0
  s_nop 5
  v_cndmask_b32 v36, v20, v25, s[44:45]
  v_cndmask_b32 v37, v24, v21, s[44:45]
  v_cndmask_b32 v38, v28, v33, s[44:45]
  v_cndmask_b32 v39, v32, v29, s[44:45]
  v_cndmask_b32 v36, v36, v30, s[46:47]
  v_cndmask_b32 v37, v37, v34, s[46:47]
  v_cndmask_b32 v38, v38, v22, s[46:47]
  v_cndmask_b32 v39, v39, v26, s[46:47]
  v_cndmask_b32 v37, v37, v31, s[48:49]
  v_cndmask_b32 v38, v38, v27, s[48:49]
  v_cndmask_b32 v39, v39, v23, s[48:49]
  v_cndmask_b32 v36, v36, v35, s[48:49]
  v_add_f32_dpp v36, v37, v36 quad_perm:[1,0,3,2] row_mask:0xf bank_mask:0xf
  v_add_f32_dpp v36, v38, v36 quad_perm:[2,3,0,1] row_mask:0xf bank_mask:0xf
  v_add_f32_dpp v36, v39, v36 quad_perm:[3,2,1,0] row_mask:0xf bank_mask:0xf
  v_cvt_pk_bf16_f32 v40, v36, v36
  v_lshlrev_b32 v36, 16, v40
  v_mul_f32 v36, s70, v36
  v_cvt_pk_bf16_f32 v40, v36, v36
  v_lshlrev_b32 v36, 16, v40
  v_mul_f32 v36, s71, v36
  ds_write_b32 v58, v36 offset:2048
  v_max_f32 v18, v18, v36
  s_waitcnt vmcnt(16)
  v_mfma_f32_16x16x32_bf16 v[20:23], v[208:211], v[6:9], 0
  v_mfma_f32_16x16x32_bf16 v[24:27], v[212:215], v[6:9], 0
  v_mfma_f32_16x16x32_bf16 v[28:31], v[216:219], v[6:9], 0
  v_mfma_f32_16x16x32_bf16 v[32:35], v[220:223], v[6:9], 0
  s_nop 5
  v_cndmask_b32 v36, v20, v25, s[44:45]
  v_cndmask_b32 v37, v24, v21, s[44:45]
  v_cndmask_b32 v38, v28, v33, s[44:45]
  v_cndmask_b32 v39, v32, v29, s[44:45]
  v_cndmask_b32 v36, v36, v30, s[46:47]
  v_cndmask_b32 v37, v37, v34, s[46:47]
  v_cndmask_b32 v38, v38, v22, s[46:47]
  v_cndmask_b32 v39, v39, v26, s[46:47]
  v_cndmask_b32 v37, v37, v31, s[48:49]
  v_cndmask_b32 v38, v38, v27, s[48:49]
  v_cndmask_b32 v39, v39, v23, s[48:49]
  v_cndmask_b32 v36, v36, v35, s[48:49]
  v_add_f32_dpp v36, v37, v36 quad_perm:[1,0,3,2] row_mask:0xf bank_mask:0xf
  v_add_f32_dpp v36, v38, v36 quad_perm:[2,3,0,1] row_mask:0xf bank_mask:0xf
  v_add_f32_dpp v36, v39, v36 quad_perm:[3,2,1,0] row_mask:0xf bank_mask:0xf
  v_cvt_pk_bf16_f32 v40, v36, v36
  v_lshlrev_b32 v36, 16, v40
  v_mul_f32 v36, s70, v36
  v_cvt_pk_bf16_f32 v40, v36, v36
  v_lshlrev_b32 v36, 16, v40
  v_mul_f32 v36, s71, v36
  ds_write_b32 v58, v36 offset:2304
  v_max_f32 v18, v18, v36
  s_waitcnt vmcnt(12)
  v_mfma_f32_16x16x32_bf16 v[20:23], v[224:227], v[6:9], 0
  v_mfma_f32_16x16x32_bf16 v[24:27], v[228:231], v[6:9], 0
  v_mfma_f32_16x16x32_bf16 v[28:31], v[232:235], v[6:9], 0
  v_mfma_f32_16x16x32_bf16 v[32:35], v[236:239], v[6:9], 0
  s_nop 5
  v_cndmask_b32 v36, v20, v25, s[44:45]
  v_cndmask_b32 v37, v24, v21, s[44:45]
  v_cndmask_b32 v38, v28, v33, s[44:45]
  v_cndmask_b32 v39, v32, v29, s[44:45]
  v_cndmask_b32 v36, v36, v30, s[46:47]
  v_cndmask_b32 v37, v37, v34, s[46:47]
  v_cndmask_b32 v38, v38, v22, s[46:47]
  v_cndmask_b32 v39, v39, v26, s[46:47]
  v_cndmask_b32 v37, v37, v31, s[48:49]
  v_cndmask_b32 v38, v38, v27, s[48:49]
  v_cndmask_b32 v39, v39, v23, s[48:49]
  v_cndmask_b32 v36, v36, v35, s[48:49]
  v_add_f32_dpp v36, v37, v36 quad_perm:[1,0,3,2] row_mask:0xf bank_mask:0xf
  v_add_f32_dpp v36, v38, v36 quad_perm:[2,3,0,1] row_mask:0xf bank_mask:0xf
  v_add_f32_dpp v36, v39, v36 quad_perm:[3,2,1,0] row_mask:0xf bank_mask:0xf
  v_cvt_pk_bf16_f32 v40, v36, v36
  v_lshlrev_b32 v36, 16, v40
  v_mul_f32 v36, s70, v36
  v_cvt_pk_bf16_f32 v40, v36, v36
  v_lshlrev_b32 v36, 16, v40
  v_mul_f32 v36, s71, v36
  ds_write_b32 v58, v36 offset:2560
  v_max_f32 v18, v18, v36
  s_waitcnt vmcnt(8)
  v_mfma_f32_16x16x32_bf16 v[20:23], v[240:243], v[6:9], 0
  v_mfma_f32_16x16x32_bf16 v[24:27], v[244:247], v[6:9], 0
  v_mfma_f32_16x16x32_bf16 v[28:31], v[248:251], v[6:9], 0
  v_mfma_f32_16x16x32_bf16 v[32:35], v[252:255], v[6:9], 0
  s_nop 5
  v_cndmask_b32 v36, v20, v25, s[44:45]
  v_cndmask_b32 v37, v24, v21, s[44:45]
  v_cndmask_b32 v38, v28, v33, s[44:45]
  v_cndmask_b32 v39, v32, v29, s[44:45]
  v_cndmask_b32 v36, v36, v30, s[46:47]
  v_cndmask_b32 v37, v37, v34, s[46:47]
  v_cndmask_b32 v38, v38, v22, s[46:47]
  v_cndmask_b32 v39, v39, v26, s[46:47]
  v_cndmask_b32 v37, v37, v31, s[48:49]
  v_cndmask_b32 v38, v38, v27, s[48:49]
  v_cndmask_b32 v39, v39, v23, s[48:49]
  v_cndmask_b32 v36, v36, v35, s[48:49]
  v_add_f32_dpp v36, v37, v36 quad_perm:[1,0,3,2] row_mask:0xf bank_mask:0xf
  v_add_f32_dpp v36, v38, v36 quad_perm:[2,3,0,1] row_mask:0xf bank_mask:0xf
  v_add_f32_dpp v36, v39, v36 quad_perm:[3,2,1,0] row_mask:0xf bank_mask:0xf
  v_cvt_pk_bf16_f32 v40, v36, v36
  v_lshlrev_b32 v36, 16, v40
  v_mul_f32 v36, s70, v36
  v_cvt_pk_bf16_f32 v40, v36, v36
  v_lshlrev_b32 v36, 16, v40
  v_mul_f32 v36, s71, v36
  ds_write_b32 v58, v36 offset:2816
  v_max_f32 v18, v18, v36
  v_add_u32 v58, 3072, v58
  s_sub_u32 s73, s83, 14
  s_lshr_b32 s73, s73, 1
L_kloop:
  s_waitcnt vmcnt(4)
  v_mfma_f32_16x16x32_bf16 v[20:23], v[64:67], v[6:9], 0
  v_mfma_f32_16x16x32_bf16 v[24:27], v[68:71], v[6:9], 0
  v_mfma_f32_16x16x32_bf16 v[28:31], v[72:75], v[6:9], 0
  v_mfma_f32_16x16x32_bf16 v[32:35], v[76:79], v[6:9], 0
  s_add_u32 s78, s81, s65
  buffer_load_dwordx4 v[64:67], v2, s[32:35], s78 offen offset:0 nt
  s_waitcnt vmcnt(4)
  buffer_load_dwordx4 v[68:71], v2, s[32:35], s78 offen offset:1024 nt
  s_waitcnt vmcnt(4)
  buffer_load_dwordx4 v[72:75], v2, s[32:35], s78 offen offset:2048 nt
  s_waitcnt vmcnt(4)
  buffer_load_dwordx4 v[76:79], v2, s[32:35], s78 offen offset:3072 nt
  s_add_u32 s65, s65, 65536
  s_and_b32 s65, s65, 2031616
  v_cndmask_b32 v36, v20, v25, s[44:45]
  v_cndmask_b32 v37, v24, v21, s[44:45]
  v_cndmask_b32 v38, v28, v33, s[44:45]
  v_cndmask_b32 v39, v32, v29, s[44:45]
  v_cndmask_b32 v36, v36, v30, s[46:47]
  v_cndmask_b32 v37, v37, v34, s[46:47]
  v_cndmask_b32 v38, v38, v22, s[46:47]
  v_cndmask_b32 v39, v39, v26, s[46:47]
  v_cndmask_b32 v37, v37, v31, s[48:49]
  v_cndmask_b32 v38, v38, v27, s[48:49]
  v_cndmask_b32 v39, v39, v23, s[48:49]
  v_cndmask_b32 v36, v36, v35, s[48:49]
  v_add_f32_dpp v36, v37, v36 quad_perm:[1,0,3,2] row_mask:0xf bank_mask:0xf
  v_add_f32_dpp v36, v38, v36 quad_perm:[2,3,0,1] row_mask:0xf bank_mask:0xf
  v_add_f32_dpp v36, v39, v36 quad_perm:[3,2,1,0] row_mask:0xf bank_mask:0xf
  v_cvt_pk_bf16_f32 v40, v36, v36
  v_lshlrev_b32 v36, 16, v40
  v_mul_f32 v36, s70, v36
  v_cvt_pk_bf16_f32 v40, v36, v36
  v_lshlrev_b32 v36, 16, v40
  v_mul_f32 v36, s71, v36
  ds_write_b32 v58, v36 offset:0
  v_max_f32 v18, v18, v36
  s_waitcnt vmcnt(4)
  v_mfma_f32_16x16x32_bf16 v[20:23], v[80:83], v[6:9], 0
  v_mfma_f32_16x16x32_bf16 v[24:27], v[84:87], v[6:9], 0
  v_mfma_f32_16x16x32_bf16 v[28:31], v[88:91], v[6:9], 0
  v_mfma_f32_16x16x32_bf16 v[32:35], v[92:95], v[6:9], 0
  s_add_u32 s78, s81, s65
  buffer_load_dwordx4 v[80:83], v2, s[32:35], s78 offen offset:0 nt
  s_waitcnt vmcnt(4)
  buffer_load_dwordx4 v[84:87], v2, s[32:35], s78 offen offset:1024 nt
  s_waitcnt vmcnt(4)
  buffer_load_dwordx4 v[88:91], v2, s[32:35], s78 offen offset:2048 nt
  s_waitcnt vmcnt(4)
  buffer_load_dwordx4 v[92:95], v2, s[32:35], s78 offen offset:3072 nt
  s_add_u32 s65, s65, 65536
  s_and_b32 s65, s65, 2031616
  v_cndmask_b32 v36, v20, v25, s[44:45]
  v_cndmask_b32 v37, v24, v21, s[44:45]
  v_cndmask_b32 v38, v28, v33, s[44:45]
  v_cndmask_b32 v39, v32, v29, s[44:45]
  v_cndmask_b32 v36, v36, v30, s[46:47]
  v_cndmask_b32 v37, v37, v34, s[46:47]
  v_cndmask_b32 v38, v38, v22, s[46:47]
  v_cndmask_b32 v39, v39, v26, s[46:47]
  v_cndmask_b32 v37, v37, v31, s[48:49]
  v_cndmask_b32 v38, v38, v27, s[48:49]
  v_cndmask_b32 v39, v39, v23, s[48:49]
  v_cndmask_b32 v36, v36, v35, s[48:49]
  v_add_f32_dpp v36, v37, v36 quad_perm:[1,0,3,2] row_mask:0xf bank_mask:0xf
  v_add_f32_dpp v36, v38, v36 quad_perm:[2,3,0,1] row_mask:0xf bank_mask:0xf
  v_add_f32_dpp v36, v39, v36 quad_perm:[3,2,1,0] row_mask:0xf bank_mask:0xf
  v_cvt_pk_bf16_f32 v40, v36, v36
  v_lshlrev_b32 v36, 16, v40
  v_mul_f32 v36, s70, v36
  v_cvt_pk_bf16_f32 v40, v36, v36
  v_lshlrev_b32 v36, 16, v40
  v_mul_f32 v36, s71, v36
  ds_write_b32 v58, v36 offset:256
  v_max_f32 v18, v18, v36
  v_add_u32 v58, 512, v58
  s_sub_u32 s73, s73, 1
  s_cmp_lg_u32 s73, 0
  s_cbranch_scc1 L_kloop
  s_waitcnt vmcnt(4)
  v_mfma_f32_16x16x32_bf16 v[20:23], v[64:67], v[6:9], 0
  v_mfma_f32_16x16x32_bf16 v[24:27], v[68:71], v[6:9], 0
  v_mfma_f32_16x16x32_bf16 v[28:31], v[72:75], v[6:9], 0
  v_mfma_f32_16x16x32_bf16 v[32:35], v[76:79], v[6:9], 0
  s_cmp_eq_u32 s82, 0
  s_cselect_b32 s38, s38, 0
  buffer_load_dwordx4 v[64:67], v3, s[36:39], s95 offen offset:0 nt
  s_waitcnt vmcnt(4)
  buffer_load_dwordx4 v[68:71], v3, s[36:39], s95 offen offset:1024 nt
  s_waitcnt vmcnt(4)
  buffer_load_dwordx4 v[72:75], v3, s[36:39], s95 offen offset:2048 nt
  s_waitcnt vmcnt(4)
  buffer_load_dwordx4 v[76:79], v3, s[36:39], s95 offen offset:3072 nt
  s_mov_b32 s38, 0x8000000
  v_cndmask_b32 v36, v20, v25, s[44:45]
  v_cndmask_b32 v37, v24, v21, s[44:45]
  v_cndmask_b32 v38, v28, v33, s[44:45]
  v_cndmask_b32 v39, v32, v29, s[44:45]
  v_cndmask_b32 v36, v36, v30, s[46:47]
  v_cndmask_b32 v37, v37, v34, s[46:47]
  v_cndmask_b32 v38, v38, v22, s[46:47]
  v_cndmask_b32 v39, v39, v26, s[46:47]
  v_cndmask_b32 v37, v37, v31, s[48:49]
  v_cndmask_b32 v38, v38, v27, s[48:49]
  v_cndmask_b32 v39, v39, v23, s[48:49]
  v_cndmask_b32 v36, v36, v35, s[48:49]
  v_add_f32_dpp v36, v37, v36 quad_perm:[1,0,3,2] row_mask:0xf bank_mask:0xf
  v_add_f32_dpp v36, v38, v36 quad_perm:[2,3,0,1] row_mask:0xf bank_mask:0xf
  v_add_f32_dpp v36, v39, v36 quad_perm:[3,2,1,0] row_mask:0xf bank_mask:0xf
  v_cvt_pk_bf16_f32 v40, v36, v36
  v_lshlrev_b32 v36, 16, v40
  v_mul_f32 v36, s70, v36
  v_cvt_pk_bf16_f32 v40, v36, v36
  v_lshlrev_b32 v36, 16, v40
  v_mul_f32 v36, s71, v36
  ds_write_b32 v58, v36 offset:0
  v_max_f32 v18, v18, v36
  s_waitcnt vmcnt(4)
  v_mfma_f32_16x16x32_bf16 v[20:23], v[80:83], v[6:9], 0
  v_mfma_f32_16x16x32_bf16 v[24:27], v[84:87], v[6:9], 0
  v_mfma_f32_16x16x32_bf16 v[28:31], v[88:91], v[6:9], 0
  v_mfma_f32_16x16x32_bf16 v[32:35], v[92:95], v[6:9], 0
  s_add_u32 s78, s81, s79
  buffer_load_dwordx4 v[80:83], v3, s[36:39], s78 offen offset:0 nt
  s_waitcnt vmcnt(4)
  buffer_load_dwordx4 v[84:87], v3, s[36:39], s78 offen offset:1024 nt
  s_waitcnt vmcnt(4)
  buffer_load_dwordx4 v[88:91], v3, s[36:39], s78 offen offset:2048 nt
  s_waitcnt vmcnt(4)
  buffer_load_dwordx4 v[92:95], v3, s[36:39], s78 offen offset:3072 nt
  s_sub_u32 s79, s79, 65536
  s_and_b32 s79, s79, 2031616
  v_cndmask_b32 v36, v20, v25, s[44:45]
  v_cndmask_b32 v37, v24, v21, s[44:45]
  v_cndmask_b32 v38, v28, v33, s[44:45]
  v_cndmask_b32 v39, v32, v29, s[44:45]
  v_cndmask_b32 v36, v36, v30, s[46:47]
  v_cndmask_b32 v37, v37, v34, s[46:47]
  v_cndmask_b32 v38, v38, v22, s[46:47]
  v_cndmask_b32 v39, v39, v26, s[46:47]
  v_cndmask_b32 v37, v37, v31, s[48:49]
  v_cndmask_b32 v38, v38, v27, s[48:49]
  v_cndmask_b32 v39, v39, v23, s[48:49]
  v_cndmask_b32 v36, v36, v35, s[48:49]
  v_add_f32_dpp v36, v37, v36 quad_perm:[1,0,3,2] row_mask:0xf bank_mask:0xf
  v_add_f32_dpp v36, v38, v36 quad_perm:[2,3,0,1] row_mask:0xf bank_mask:0xf
  v_add_f32_dpp v36, v39, v36 quad_perm:[3,2,1,0] row_mask:0xf bank_mask:0xf
  v_cvt_pk_bf16_f32 v40, v36, v36
  v_lshlrev_b32 v36, 16, v40
  v_mul_f32 v36, s70, v36
  v_cvt_pk_bf16_f32 v40, v36, v36
  v_lshlrev_b32 v36, 16, v40
  v_mul_f32 v36, s71, v36
  ds_write_b32 v58, v36 offset:256
  v_max_f32 v18, v18, v36
  s_nop 1
  v_max_f32_dpp v18, v18, v18 quad_perm:[1,0,3,2] row_mask:0xf bank_mask:0xf
  s_nop 1
  v_max_f32_dpp v18, v18, v18 quad_perm:[2,3,0,1] row_mask:0xf bank_mask:0xf
  v_mov_b32 v43, v18
  s_nop 1
  v_permlane16_swap_b32 v18, v43
  v_max_f32 v18, v18, v43
  v_mov_b32 v43, v18
  s_nop 1
  v_permlane32_swap_b32 v18, v43
  v_max_f32 v18, v18, v43
  v_add_u32 v59, 256, v58
  s_lshr_b32 s73, s83, 1
  s_sub_u32 s73, s73, 1
  s_mov_b32 s74, 1
L_vloop:
  ds_read2st64_b32 v[42:43], v59 offset1:1
  v_subrev_u32 v59, 512, v59
  s_waitcnt lgkmcnt(0)
  s_cmp_lg_u32 s73, 0
  s_cbranch_scc1 L_vnc
  s_atomic_add s74, s[76:77], 0 glc
L_vnc:
  v_sub_f32 v36, v43, v18
  v_exp_f32 v36, v36
  s_nop 0
  v_cvt_pk_bf16_f32 v37, v36, v36
  v_add_f32 v19, v19, v36
  s_nop 0
  v_and_b32_dpp v48, v37, v4 quad_perm:[0,0,0,0] row_mask:0xf bank_mask:0xf
  v_and_b32_dpp v49, v37, v5 quad_perm:[0,0,0,0] row_mask:0xf bank_mask:0xf
  v_and_b32_dpp v50, v37, v4 quad_perm:[1,1,1,1] row_mask:0xf bank_mask:0xf
  v_and_b32_dpp v51, v37, v5 quad_perm:[1,1,1,1] row_mask:0xf bank_mask:0xf
  v_and_b32_dpp v52, v37, v4 quad_perm:[2,2,2,2] row_mask:0xf bank_mask:0xf
  v_and_b32_dpp v53, v37, v5 quad_perm:[2,2,2,2] row_mask:0xf bank_mask:0xf
  v_and_b32_dpp v54, v37, v4 quad_perm:[3,3,3,3] row_mask:0xf bank_mask:0xf
  v_and_b32_dpp v55, v37, v5 quad_perm:[3,3,3,3] row_mask:0xf bank_mask:0xf
  s_waitcnt vmcnt(4)
  v_mfma_f32_16x16x16_bf16 v[10:13], v[64:65], v[48:49], v[10:13]
  v_mfma_f32_16x16x16_bf16 v[14:17], v[66:67], v[48:49], v[14:17]
  v_mfma_f32_16x16x16_bf16 v[10:13], v[68:69], v[50:51], v[10:13]
  v_mfma_f32_16x16x16_bf16 v[14:17], v[70:71], v[50:51], v[14:17]
  v_mfma_f32_16x16x16_bf16 v[10:13], v[72:73], v[52:53], v[10:13]
  v_mfma_f32_16x16x16_bf16 v[14:17], v[74:75], v[52:53], v[14:17]
  v_mfma_f32_16x16x16_bf16 v[10:13], v[76:77], v[54:55], v[10:13]
  v_mfma_f32_16x16x16_bf16 v[14:17], v[78:79], v[54:55], v[14:17]
  s_add_u32 s78, s81, s79
  buffer_load_dwordx4 v[64:67], v3, s[36:39], s78 offen offset:0 nt
  s_waitcnt vmcnt(4)
  buffer_load_dwordx4 v[68:71], v3, s[36:39], s78 offen offset:1024 nt
  s_waitcnt vmcnt(4)
  buffer_load_dwordx4 v[72:75], v3, s[36:39], s78 offen offset:2048 nt
  s_waitcnt vmcnt(4)
  buffer_load_dwordx4 v[76:79], v3, s[36:39], s78 offen offset:3072 nt
  s_sub_u32 s79, s79, 65536
  s_and_b32 s79, s79, 2031616
  v_sub_f32 v36, v42, v18
  v_exp_f32 v36, v36
  s_nop 0
  v_cvt_pk_bf16_f32 v37, v36, v36
  v_add_f32 v19, v19, v36
  s_nop 0
  v_and_b32_dpp v48, v37, v4 quad_perm:[0,0,0,0] row_mask:0xf bank_mask:0xf
  v_and_b32_dpp v49, v37, v5 quad_perm:[0,0,0,0] row_mask:0xf bank_mask:0xf
  v_and_b32_dpp v50, v37, v4 quad_perm:[1,1,1,1] row_mask:0xf bank_mask:0xf
  v_and_b32_dpp v51, v37, v5 quad_perm:[1,1,1,1] row_mask:0xf bank_mask:0xf
  v_and_b32_dpp v52, v37, v4 quad_perm:[2,2,2,2] row_mask:0xf bank_mask:0xf
  v_and_b32_dpp v53, v37, v5 quad_perm:[2,2,2,2] row_mask:0xf bank_mask:0xf
  v_and_b32_dpp v54, v37, v4 quad_perm:[3,3,3,3] row_mask:0xf bank_mask:0xf
  v_and_b32_dpp v55, v37, v5 quad_perm:[3,3,3,3] row_mask:0xf bank_mask:0xf
  s_waitcnt vmcnt(4)
  v_mfma_f32_16x16x16_bf16 v[10:13], v[80:81], v[48:49], v[10:13]
  v_mfma_f32_16x16x16_bf16 v[14:17], v[82:83], v[48:49], v[14:17]
  v_mfma_f32_16x16x16_bf16 v[10:13], v[84:85], v[50:51], v[10:13]
  v_mfma_f32_16x16x16_bf16 v[14:17], v[86:87], v[50:51], v[14:17]
  v_mfma_f32_16x16x16_bf16 v[10:13], v[88:89], v[52:53], v[10:13]
  v_mfma_f32_16x16x16_bf16 v[14:17], v[90:91], v[52:53], v[14:17]
  v_mfma_f32_16x16x16_bf16 v[10:13], v[92:93], v[54:55], v[10:13]
  v_mfma_f32_16x16x16_bf16 v[14:17], v[94:95], v[54:55], v[14:17]
  s_add_u32 s78, s81, s79
  buffer_load_dwordx4 v[80:83], v3, s[36:39], s78 offen offset:0 nt
  s_waitcnt vmcnt(4)
  buffer_load_dwordx4 v[84:87], v3, s[36:39], s78 offen offset:1024 nt
  s_waitcnt vmcnt(4)
  buffer_load_dwordx4 v[88:91], v3, s[36:39], s78 offen offset:2048 nt
  s_waitcnt vmcnt(4)
  buffer_load_dwordx4 v[92:95], v3, s[36:39], s78 offen offset:3072 nt
  s_sub_u32 s79, s79, 65536
  s_and_b32 s79, s79, 2031616
  s_sub_u32 s73, s73, 1
  s_cmp_lg_u32 s73, 0
  s_cbranch_scc1 L_vloop
  ds_read2st64_b32 v[42:43], v59 offset1:1
  s_waitcnt lgkmcnt(0)
  s_atomic_add s74, s[76:77], 0 glc
  v_sub_f32 v36, v43, v18
  v_exp_f32 v36, v36
  s_nop 0
  v_cvt_pk_bf16_f32 v37, v36, v36
  v_add_f32 v19, v19, v36
  s_nop 0
  v_and_b32_dpp v48, v37, v4 quad_perm:[0,0,0,0] row_mask:0xf bank_mask:0xf
  v_and_b32_dpp v49, v37, v5 quad_perm:[0,0,0,0] row_mask:0xf bank_mask:0xf
  v_and_b32_dpp v50, v37, v4 quad_perm:[1,1,1,1] row_mask:0xf bank_mask:0xf
  v_and_b32_dpp v51, v37, v5 quad_perm:[1,1,1,1] row_mask:0xf bank_mask:0xf
  v_and_b32_dpp v52, v37, v4 quad_perm:[2,2,2,2] row_mask:0xf bank_mask:0xf
  v_and_b32_dpp v53, v37, v5 quad_perm:[2,2,2,2] row_mask:0xf bank_mask:0xf
  v_and_b32_dpp v54, v37, v4 quad_perm:[3,3,3,3] row_mask:0xf bank_mask:0xf
  v_and_b32_dpp v55, v37, v5 quad_perm:[3,3,3,3] row_mask:0xf bank_mask:0xf
  s_waitcnt vmcnt(4)
  v_mfma_f32_16x16x16_bf16 v[10:13], v[64:65], v[48:49], v[10:13]
  v_mfma_f32_16x16x16_bf16 v[14:17], v[66:67], v[48:49], v[14:17]
  v_mfma_f32_16x16x16_bf16 v[10:13], v[68:69], v[50:51], v[10:13]
  v_mfma_f32_16x16x16_bf16 v[14:17], v[70:71], v[50:51], v[14:17]
  v_mfma_f32_16x16x16_bf16 v[10:13], v[72:73], v[52:53], v[10:13]
  v_mfma_f32_16x16x16_bf16 v[14:17], v[74:75], v[52:53], v[14:17]
  v_mfma_f32_16x16x16_bf16 v[10:13], v[76:77], v[54:55], v[10:13]
  v_mfma_f32_16x16x16_bf16 v[14:17], v[78:79], v[54:55], v[14:17]
  s_waitcnt lgkmcnt(0)
  s_bfe_u32 s75, s74, 131074
  s_lshr_b32 s69, s74, 4
  s_add_u32 s69, s69, 2
  s_sub_u32 s92, s74, 32
  s_bfe_u32 s93, s92, 196610
  s_lshr_b32 s92, s92, 5
  s_cmp_lt_u32 s74, 32
  s_cselect_b32 s75, s75, s93
  s_cselect_b32 s69, s69, s92
  s_add_u32 s69, s69, s94
  s_and_b32 s69, s69, 31
  s_lshl_b32 s69, s69, 16
  s_and_b32 s92, s75, 3
  s_lshl_b32 s92, s92, 14
  s_add_u32 s69, s69, s92
  s_lshr_b32 s75, s75, 2
  s_lshl_b32 s75, s75, 21
  s_add_u32 s75, s75, s69
  s_and_b32 s69, s74, 3
  s_lshl_b32 s69, s69, 12
  s_add_u32 s75, s75, s69
  s_add_u32 s78, s75, s68
  s_cmp_lt_u32 s74, 96
  s_cselect_b32 s80, 1, 0
  s_cselect_b32 s78, s78, 0
  s_cselect_b32 s34, s34, 0
  s_cselect_b32 s38, s38, 0
  buffer_load_dwordx4 v[96:99], v2, s[32:35], s78 offen offset:0 nt
  buffer_load_dwordx4 v[100:103], v2, s[32:35], s78 offen offset:1024 nt
  buffer_load_dwordx4 v[104:107], v2, s[32:35], s78 offen offset:2048 nt
  buffer_load_dwordx4 v[108:111], v2, s[32:35], s78 offen offset:3072 nt
  buffer_load_dwordx4 v[112:115], v3, s[36:39], s78 offen offset:0 nt
  buffer_load_dwordx4 v[116:119], v3, s[36:39], s78 offen offset:1024 nt
  buffer_load_dwordx4 v[120:123], v3, s[36:39], s78 offen offset:2048 nt
  buffer_load_dwordx4 v[124:127], v3, s[36:39], s78 offen offset:3072 nt
  v_sub_f32 v36, v42, v18
  v_exp_f32 v36, v36
  s_nop 0
  v_cvt_pk_bf16_f32 v37, v36, v36
  v_add_f32 v19, v19, v36
  s_nop 0
  v_and_b32_dpp v48, v37, v4 quad_perm:[0,0,0,0] row_mask:0xf bank_mask:0xf
  v_and_b32_dpp v49, v37, v5 quad_perm:[0,0,0,0] row_mask:0xf bank_mask:0xf
  v_and_b32_dpp v50, v37, v4 quad_perm:[1,1,1,1] row_mask:0xf bank_mask:0xf
  v_and_b32_dpp v51, v37, v5 quad_perm:[1,1,1,1] row_mask:0xf bank_mask:0xf
  v_and_b32_dpp v52, v37, v4 quad_perm:[2,2,2,2] row_mask:0xf bank_mask:0xf
  v_and_b32_dpp v53, v37, v5 quad_perm:[2,2,2,2] row_mask:0xf bank_mask:0xf
  v_and_b32_dpp v54, v37, v4 quad_perm:[3,3,3,3] row_mask:0xf bank_mask:0xf
  v_and_b32_dpp v55, v37, v5 quad_perm:[3,3,3,3] row_mask:0xf bank_mask:0xf
  s_waitcnt vmcnt(8)
  v_mfma_f32_16x16x16_bf16 v[10:13], v[80:81], v[48:49], v[10:13]
  v_mfma_f32_16x16x16_bf16 v[14:17], v[82:83], v[48:49], v[14:17]
  v_mfma_f32_16x16x16_bf16 v[10:13], v[84:85], v[50:51], v[10:13]
  v_mfma_f32_16x16x16_bf16 v[14:17], v[86:87], v[50:51], v[14:17]
  v_mfma_f32_16x16x16_bf16 v[10:13], v[88:89], v[52:53], v[10:13]
  v_mfma_f32_16x16x16_bf16 v[14:17], v[90:91], v[52:53], v[14:17]
  v_mfma_f32_16x16x16_bf16 v[10:13], v[92:93], v[54:55], v[10:13]
  v_mfma_f32_16x16x16_bf16 v[14:17], v[94:95], v[54:55], v[14:17]
  s_cmp_eq_u32 s80, 0
  s_cbranch_scc1 L_done
  s_mov_b32 s74, 1
  s_atomic_add s74, s[76:77], 0 glc
  s_branch L_main1
  s_cmp_eq_u32 s80, 0
  s_cbranch_scc1 L_done
L_main:
  s_waitcnt lgkmcnt(0)
  s_bfe_u32 s75, s74, 131074
  s_lshr_b32 s69, s74, 4
  s_add_u32 s69, s69, 2
  s_sub_u32 s92, s74, 32
  s_bfe_u32 s93, s92, 196610
  s_lshr_b32 s92, s92, 5
  s_cmp_lt_u32 s74, 32
  s_cselect_b32 s75, s75, s93
  s_cselect_b32 s69, s69, s92
  s_add_u32 s69, s69, s94
  s_and_b32 s69, s69, 31
  s_lshl_b32 s69, s69, 16
  s_and_b32 s92, s75, 3
  s_lshl_b32 s92, s92, 14
  s_add_u32 s69, s69, s92
  s_lshr_b32 s75, s75, 2
  s_lshl_b32 s75, s75, 21
  s_add_u32 s75, s75, s69
  s_and_b32 s69, s74, 3
  s_lshl_b32 s69, s69, 12
  s_add_u32 s75, s75, s69
  s_add_u32 s78, s75, s68
  s_cmp_lt_u32 s74, 96
  s_cselect_b32 s80, 1, 0
  s_cselect_b32 s78, s78, 0
  s_cselect_b32 s34, s34, 0
  s_cselect_b32 s38, s38, 0
  buffer_load_dwordx4 v[96:99], v2, s[32:35], s78 offen offset:0 nt
  buffer_load_dwordx4 v[100:103], v2, s[32:35], s78 offen offset:1024 nt
  buffer_load_dwordx4 v[104:107], v2, s[32:35], s78 offen offset:2048 nt
  buffer_load_dwordx4 v[108:111], v2, s[32:35], s78 offen offset:3072 nt
  buffer_load_dwordx4 v[112:115], v3, s[36:39], s78 offen offset:0 nt
  buffer_load_dwordx4 v[116:119], v3, s[36:39], s78 offen offset:1024 nt
  buffer_load_dwordx4 v[120:123], v3, s[36:39], s78 offen offset:2048 nt
  buffer_load_dwordx4 v[124:127], v3, s[36:39], s78 offen offset:3072 nt
  s_waitcnt vmcnt(12)
  v_mfma_f32_16x16x32_bf16 v[20:23], v[64:67], v[6:9], 0
  v_mfma_f32_16x16x32_bf16 v[24:27], v[68:71], v[6:9], 0
  v_mfma_f32_16x16x32_bf16 v[28:31], v[72:75], v[6:9], 0
  v_mfma_f32_16x16x32_bf16 v[32:35], v[76:79], v[6:9], 0
  s_cmp_eq_u32 s80, 0
  s_cbranch_scc1 L_nc22
  s_mov_b32 s74, 1
  s_atomic_add s74, s[76:77], 0 glc
L_nc22:
  s_nop 3
  v_cndmask_b32 v36, v20, v25, s[44:45]
  v_cndmask_b32 v37, v24, v21, s[44:45]
  v_cndmask_b32 v38, v28, v33, s[44:45]
  v_cndmask_b32 v39, v32, v29, s[44:45]
  v_cndmask_b32 v36, v36, v30, s[46:47]
  v_cndmask_b32 v37, v37, v34, s[46:47]
  v_cndmask_b32 v38, v38, v22, s[46:47]
  v_cndmask_b32 v39, v39, v26, s[46:47]
  v_cndmask_b32 v37, v37, v31, s[48:49]
  v_cndmask_b32 v38, v38, v27, s[48:49]
  v_cndmask_b32 v39, v39, v23, s[48:49]
  v_cndmask_b32 v36, v36, v35, s[48:49]
  v_add_f32_dpp v36, v37, v36 quad_perm:[1,0,3,2] row_mask:0xf bank_mask:0xf
  v_add_f32_dpp v36, v38, v36 quad_perm:[2,3,0,1] row_mask:0xf bank_mask:0xf
  v_add_f32_dpp v36, v39, v36 quad_perm:[3,2,1,0] row_mask:0xf bank_mask:0xf
  v_cvt_pk_bf16_f32 v40, v36, v36
  v_lshlrev_b32 v36, 16, v40
  v_mul_f32 v36, s70, v36
  v_cvt_pk_bf16_f32 v40, v36, v36
  v_lshlrev_b32 v36, 16, v40
  v_mul_f32 v36, s71, v36
  v_cmp_gt_f32 vcc, v36, v18
  s_cbranch_vccz L_sk0
  v_max_f32 v42, v36, v18
  s_nop 1
  v_max_f32_dpp v42, v42, v42 quad_perm:[1,0,3,2] row_mask:0xf bank_mask:0xf
  s_nop 1
  v_max_f32_dpp v42, v42, v42 quad_perm:[2,3,0,1] row_mask:0xf bank_mask:0xf
  v_mov_b32 v43, v42
  s_nop 1
  v_permlane16_swap_b32 v42, v43
  v_max_f32 v42, v42, v43
  v_mov_b32 v43, v42
  s_nop 1
  v_permlane32_swap_b32 v42, v43
  v_max_f32 v42, v42, v43
  v_sub_f32 v44, v18, v42
  v_exp_f32 v44, v44
  v_mov_b32 v18, v42
  v_pk_mul_f32 v[10:11], v[10:11], v[44:45] op_sel_hi:[1,0]
  v_pk_mul_f32 v[12:13], v[12:13], v[44:45] op_sel_hi:[1,0]
  v_pk_mul_f32 v[14:15], v[14:15], v[44:45] op_sel_hi:[1,0]
  v_pk_mul_f32 v[16:17], v[16:17], v[44:45] op_sel_hi:[1,0]
  v_mul_f32 v19, v19, v44
L_sk0:
  v_sub_f32 v36, v36, v18
  v_exp_f32 v36, v36
  s_nop 0
  v_cvt_pk_bf16_f32 v37, v36, v36
  v_add_f32 v19, v19, v36
  s_nop 0
  v_and_b32_dpp v48, v37, v4 quad_perm:[0,0,0,0] row_mask:0xf bank_mask:0xf
  v_and_b32_dpp v49, v37, v5 quad_perm:[0,0,0,0] row_mask:0xf bank_mask:0xf
  v_and_b32_dpp v50, v37, v4 quad_perm:[1,1,1,1] row_mask:0xf bank_mask:0xf
  v_and_b32_dpp v51, v37, v5 quad_perm:[1,1,1,1] row_mask:0xf bank_mask:0xf
  v_and_b32_dpp v52, v37, v4 quad_perm:[2,2,2,2] row_mask:0xf bank_mask:0xf
  v_and_b32_dpp v53, v37, v5 quad_perm:[2,2,2,2] row_mask:0xf bank_mask:0xf
  v_and_b32_dpp v54, v37, v4 quad_perm:[3,3,3,3] row_mask:0xf bank_mask:0xf
  v_and_b32_dpp v55, v37, v5 quad_perm:[3,3,3,3] row_mask:0xf bank_mask:0xf
  s_waitcnt vmcnt(8)
  v_mfma_f32_16x16x16_bf16 v[10:13], v[80:81], v[48:49], v[10:13]
  v_mfma_f32_16x16x16_bf16 v[14:17], v[82:83], v[48:49], v[14:17]
  v_mfma_f32_16x16x16_bf16 v[10:13], v[84:85], v[50:51], v[10:13]
  v_mfma_f32_16x16x16_bf16 v[14:17], v[86:87], v[50:51], v[14:17]
  v_mfma_f32_16x16x16_bf16 v[10:13], v[88:89], v[52:53], v[10:13]
  v_mfma_f32_16x16x16_bf16 v[14:17], v[90:91], v[52:53], v[14:17]
  v_mfma_f32_16x16x16_bf16 v[10:13], v[92:93], v[54:55], v[10:13]
  v_mfma_f32_16x16x16_bf16 v[14:17], v[94:95], v[54:55], v[14:17]
  s_cmp_eq_u32 s80, 0
  s_cbranch_scc1 L_done
L_main1:
  s_waitcnt lgkmcnt(0)
  s_bfe_u32 s75, s74, 131074
  s_lshr_b32 s69, s74, 4
  s_add_u32 s69, s69, 2
  s_sub_u32 s92, s74, 32
  s_bfe_u32 s93, s92, 196610
  s_lshr_b32 s92, s92, 5
  s_cmp_lt_u32 s74, 32
  s_cselect_b32 s75, s75, s93
  s_cselect_b32 s69, s69, s92
  s_add_u32 s69, s69, s94
  s_and_b32 s69, s69, 31
  s_lshl_b32 s69, s69, 16
  s_and_b32 s92, s75, 3
  s_lshl_b32 s92, s92, 14
  s_add_u32 s69, s69, s92
  s_lshr_b32 s75, s75, 2
  s_lshl_b32 s75, s75, 21
  s_add_u32 s75, s75, s69
  s_and_b32 s69, s74, 3
  s_lshl_b32 s69, s69, 12
  s_add_u32 s75, s75, s69
  s_add_u32 s78, s75, s68
  s_cmp_lt_u32 s74, 96
  s_cselect_b32 s80, 1, 0
  s_cselect_b32 s78, s78, 0
  s_cselect_b32 s34, s34, 0
  s_cselect_b32 s38, s38, 0
  buffer_load_dwordx4 v[64:67], v2, s[32:35], s78 offen offset:0 nt
  buffer_load_dwordx4 v[68:71], v2, s[32:35], s78 offen offset:1024 nt
  buffer_load_dwordx4 v[72:75], v2, s[32:35], s78 offen offset:2048 nt
  buffer_load_dwordx4 v[76:79], v2, s[32:35], s78 offen offset:3072 nt
  buffer_load_dwordx4 v[80:83], v3, s[36:39], s78 offen offset:0 nt
  buffer_load_dwordx4 v[84:87], v3, s[36:39], s78 offen offset:1024 nt
  buffer_load_dwordx4 v[88:91], v3, s[36:39], s78 offen offset:2048 nt
  buffer_load_dwordx4 v[92:95], v3, s[36:39], s78 offen offset:3072 nt
  s_waitcnt vmcnt(12)
  v_mfma_f32_16x16x32_bf16 v[20:23], v[96:99], v[6:9], 0
  v_mfma_f32_16x16x32_bf16 v[24:27], v[100:103], v[6:9], 0
  v_mfma_f32_16x16x32_bf16 v[28:31], v[104:107], v[6:9], 0
  v_mfma_f32_16x16x32_bf16 v[32:35], v[108:111], v[6:9], 0
  s_cmp_eq_u32 s80, 0
  s_cbranch_scc1 L_nc23
  s_mov_b32 s74, 1
  s_atomic_add s74, s[76:77], 0 glc
L_nc23:
  s_nop 3
  v_cndmask_b32 v36, v20, v25, s[44:45]
  v_cndmask_b32 v37, v24, v21, s[44:45]
  v_cndmask_b32 v38, v28, v33, s[44:45]
  v_cndmask_b32 v39, v32, v29, s[44:45]
  v_cndmask_b32 v36, v36, v30, s[46:47]
  v_cndmask_b32 v37, v37, v34, s[46:47]
  v_cndmask_b32 v38, v38, v22, s[46:47]
  v_cndmask_b32 v39, v39, v26, s[46:47]
  v_cndmask_b32 v37, v37, v31, s[48:49]
  v_cndmask_b32 v38, v38, v27, s[48:49]
  v_cndmask_b32 v39, v39, v23, s[48:49]
  v_cndmask_b32 v36, v36, v35, s[48:49]
  v_add_f32_dpp v36, v37, v36 quad_perm:[1,0,3,2] row_mask:0xf bank_mask:0xf
  v_add_f32_dpp v36, v38, v36 quad_perm:[2,3,0,1] row_mask:0xf bank_mask:0xf
  v_add_f32_dpp v36, v39, v36 quad_perm:[3,2,1,0] row_mask:0xf bank_mask:0xf
  v_cvt_pk_bf16_f32 v40, v36, v36
  v_lshlrev_b32 v36, 16, v40
  v_mul_f32 v36, s70, v36
  v_cvt_pk_bf16_f32 v40, v36, v36
  v_lshlrev_b32 v36, 16, v40
  v_mul_f32 v36, s71, v36
  v_cmp_gt_f32 vcc, v36, v18
  s_cbranch_vccz L_sk1
  v_max_f32 v42, v36, v18
  s_nop 1
  v_max_f32_dpp v42, v42, v42 quad_perm:[1,0,3,2] row_mask:0xf bank_mask:0xf
  s_nop 1
  v_max_f32_dpp v42, v42, v42 quad_perm:[2,3,0,1] row_mask:0xf bank_mask:0xf
  v_mov_b32 v43, v42
  s_nop 1
  v_permlane16_swap_b32 v42, v43
  v_max_f32 v42, v42, v43
  v_mov_b32 v43, v42
  s_nop 1
  v_permlane32_swap_b32 v42, v43
  v_max_f32 v42, v42, v43
  v_sub_f32 v44, v18, v42
  v_exp_f32 v44, v44
  v_mov_b32 v18, v42
  v_pk_mul_f32 v[10:11], v[10:11], v[44:45] op_sel_hi:[1,0]
  v_pk_mul_f32 v[12:13], v[12:13], v[44:45] op_sel_hi:[1,0]
  v_pk_mul_f32 v[14:15], v[14:15], v[44:45] op_sel_hi:[1,0]
  v_pk_mul_f32 v[16:17], v[16:17], v[44:45] op_sel_hi:[1,0]
  v_mul_f32 v19, v19, v44
L_sk1:
  v_sub_f32 v36, v36, v18
  v_exp_f32 v36, v36
  s_nop 0
  v_cvt_pk_bf16_f32 v37, v36, v36
  v_add_f32 v19, v19, v36
  s_nop 0
  v_and_b32_dpp v48, v37, v4 quad_perm:[0,0,0,0] row_mask:0xf bank_mask:0xf
  v_and_b32_dpp v49, v37, v5 quad_perm:[0,0,0,0] row_mask:0xf bank_mask:0xf
  v_and_b32_dpp v50, v37, v4 quad_perm:[1,1,1,1] row_mask:0xf bank_mask:0xf
  v_and_b32_dpp v51, v37, v5 quad_perm:[1,1,1,1] row_mask:0xf bank_mask:0xf
  v_and_b32_dpp v52, v37, v4 quad_perm:[2,2,2,2] row_mask:0xf bank_mask:0xf
  v_and_b32_dpp v53, v37, v5 quad_perm:[2,2,2,2] row_mask:0xf bank_mask:0xf
  v_and_b32_dpp v54, v37, v4 quad_perm:[3,3,3,3] row_mask:0xf bank_mask:0xf
  v_and_b32_dpp v55, v37, v5 quad_perm:[3,3,3,3] row_mask:0xf bank_mask:0xf
  s_waitcnt vmcnt(8)
  v_mfma_f32_16x16x16_bf16 v[10:13], v[112:113], v[48:49], v[10:13]
  v_mfma_f32_16x16x16_bf16 v[14:17], v[114:115], v[48:49], v[14:17]
  v_mfma_f32_16x16x16_bf16 v[10:13], v[116:117], v[50:51], v[10:13]
  v_mfma_f32_16x16x16_bf16 v[14:17], v[118:119], v[50:51], v[14:17]
  v_mfma_f32_16x16x16_bf16 v[10:13], v[120:121], v[52:53], v[10:13]
  v_mfma_f32_16x16x16_bf16 v[14:17], v[122:123], v[52:53], v[14:17]
  v_mfma_f32_16x16x16_bf16 v[10:13], v[124:125], v[54:55], v[10:13]
  v_mfma_f32_16x16x16_bf16 v[14:17], v[126:127], v[54:55], v[14:17]
  s_cmp_lg_u32 s80, 0
  s_cbranch_scc1 L_main
L_done:
  s_nop 3
  v_add_f32_dpp v19, v19, v19 quad_perm:[1,0,3,2] row_mask:0xf bank_mask:0xf
  s_nop 1
  v_add_f32_dpp v19, v19, v19 quad_perm:[2,3,0,1] row_mask:0xf bank_mask:0xf
  v_mov_b32 v43, v19
  s_nop 1
  v_permlane16_swap_b32 v19, v43
  v_add_f32 v19, v19, v43
  v_mov_b32 v43, v19
  s_nop 1
  v_permlane32_swap_b32 v19, v43
  v_add_f32 v19, v19, v43
  ds_write_b32 v56, v10 offset:8192
  ds_write_b32 v56, v14 offset:8208
  ds_write_b32 v56, v11 offset:8224
  ds_write_b32 v56, v15 offset:8240
  ds_write_b32 v56, v12 offset:8256
  ds_write_b32 v56, v16 offset:8272
  ds_write_b32 v56, v13 offset:8288
  ds_write_b32 v56, v17 offset:8304
  ds_write_b64 v57, v[18:19] offset:16640
  s_lshl_b32 s73, s64, 3
  v_mov_b32 v45, s73
  v_mov_b32 v167, 0xfffff800
  s_waitcnt lgkmcnt(0)
  s_barrier
  ds_read_b64 v[128:129], v45 offset:16640
  ds_read_b64 v[130:131], v45 offset:16672
  ds_read_b64 v[132:133], v45 offset:16704
  ds_read_b64 v[134:135], v45 offset:16736
  ds_read_b128 v[136:139], v46 offset:8192
  ds_read_b128 v[140:143], v46 offset:10304
  ds_read_b128 v[144:147], v46 offset:12416
  ds_read_b128 v[148:151], v46 offset:14528
  s_waitcnt lgkmcnt(4)
  v_max3_f32 v164, v128, v130, v132
  v_max_f32 v164, v164, v134
  v_sub_f32 v152, v128, v164
  v_sub_f32 v154, v130, v164
  v_sub_f32 v156, v132, v164
  v_sub_f32 v158, v134, v164
  v_exp_f32 v152, v152
  v_exp_f32 v154, v154
  v_exp_f32 v156, v156
  v_exp_f32 v158, v158
  v_mul_f32 v165, v152, v129
  v_fmac_f32 v165, v154, v131
  v_fmac_f32 v165, v156, v133
  v_fmac_f32 v165, v158, v135
  v_cndmask_b32 v166, v164, v165, s[50:51]
  v_lshrrev_b32 v166, v41, v166
  v_bfe_u32 v168, v166, 0, 1
  v_bfe_u32 v169, v166, 1, 1
  v_bfe_u32 v170, v166, 2, 1
  v_bfe_u32 v171, v166, 3, 1
  v_lshl_or_b32 v168, v168, 10, s84
  v_lshl_or_b32 v169, v169, 10, s85
  v_lshl_or_b32 v170, v170, 10, s86
  v_lshl_or_b32 v171, v171, 10, s87
  s_waitcnt lgkmcnt(0)
  v_pk_mul_f32 v[160:161], v[136:137], v[152:153] op_sel_hi:[1,0]
  v_pk_mul_f32 v[162:163], v[138:139], v[152:153] op_sel_hi:[1,0]
  v_pk_fma_f32 v[160:161], v[140:141], v[154:155], v[160:161] op_sel_hi:[1,0,1]
  v_pk_fma_f32 v[162:163], v[142:143], v[154:155], v[162:163] op_sel_hi:[1,0,1]
  v_pk_fma_f32 v[160:161], v[144:145], v[156:157], v[160:161] op_sel_hi:[1,0,1]
  v_pk_fma_f32 v[162:163], v[146:147], v[156:157], v[162:163] op_sel_hi:[1,0,1]
  v_pk_fma_f32 v[160:161], v[148:149], v[158:159], v[160:161] op_sel_hi:[1,0,1]
  v_pk_fma_f32 v[162:163], v[150:151], v[158:159], v[162:163] op_sel_hi:[1,0,1]
  v_add_u32 v160, 0x400, v160
  v_add_u32 v161, 0x400, v161
  v_add_u32 v162, 0x400, v162
  v_add_u32 v163, 0x400, v163
  v_and_or_b32 v160, v160, v167, v168
  v_and_or_b32 v161, v161, v167, v169
  v_and_or_b32 v162, v162, v167, v170
  v_and_or_b32 v163, v163, v167, v171
  s_mov_b32 exec_hi, 0
  buffer_store_dwordx4 v[160:163], v47, s[40:43], s58 offen sc1
  s_mov_b64 exec, -1
  s_cmp_lt_u32 s67, 4
  s_cbranch_scc1 L_fin
  s_cmp_lg_u32 s64, 0
  s_cbranch_scc1 L_fin
  s_lshl_b32 s71, s31, 2
  s_add_u32 s71, s71, s67
  s_sub_u32 s71, s71, 4
  s_lshr_b32 s72, s71, 3
  s_lshl_b32 s72, s72, 15
  s_and_b32 s73, s71, 7
  s_lshl_b32 s73, s73, 6
  s_add_u32 s72, s72, s73
  s_add_u32 s32, s72, 524288
  s_add_u32 s33, s32, 4096
  s_add_u32 s34, s32, 8192
  s_add_u32 s35, s32, 12288
  s_add_u32 s36, s32, 16384
  s_add_u32 s37, s32, 20480
  s_add_u32 s38, s32, 24576
  s_add_u32 s39, s32, 28672
  v_and_b32 v40, 15, v1
  v_lshrrev_b32 v41, 4, v1
  v_lshlrev_b32 v41, 9, v41
  v_lshl_add_u32 v41, v40, 2, v41
  v_lshlrev_b32 v42, 3, v40
  ds_read_b64 v[48:49], v42 offset:7168
  v_mov_b32 v45, s84
  v_mov_b32 v46, s85
  v_cndmask_b32 v45, v45, v46, s[44:45]
  v_mov_b32 v46, s86
  v_cndmask_b32 v45, v45, v46, s[46:47]
  v_mov_b32 v46, s87
  v_cndmask_b32 v45, v45, v46, s[48:49]
  s_mov_b32 s52, s24
  s_and_b32 s53, s25, 0xffff
  s_mov_b32 s54, 0x1000
  s_mov_b32 s55, 0x20000
  s_lshl_b32 s75, s71, 5
  v_lshlrev_b32 v40, 1, v40
  s_mov_b32 s60, 60000
L_pl24:
  buffer_load_dword v128, v41, s[40:43], s32 offen offset:0 sc1
  buffer_load_dword v129, v41, s[40:43], s32 offen offset:2048 sc1
  buffer_load_dword v130, v41, s[40:43], s33 offen offset:0 sc1
  buffer_load_dword v131, v41, s[40:43], s33 offen offset:2048 sc1
  buffer_load_dword v132, v41, s[40:43], s34 offen offset:0 sc1
  buffer_load_dword v133, v41, s[40:43], s34 offen offset:2048 sc1
  buffer_load_dword v134, v41, s[40:43], s35 offen offset:0 sc1
  buffer_load_dword v135, v41, s[40:43], s35 offen offset:2048 sc1
  buffer_load_dword v136, v41, s[40:43], s36 offen offset:0 sc1
  buffer_load_dword v137, v41, s[40:43], s36 offen offset:2048 sc1
  buffer_load_dword v138, v41, s[40:43], s37 offen offset:0 sc1
  buffer_load_dword v139, v41, s[40:43], s37 offen offset:2048 sc1
  buffer_load_dword v140, v41, s[40:43], s38 offen offset:0 sc1
  buffer_load_dword v141, v41, s[40:43], s38 offen offset:2048 sc1
  buffer_load_dword v142, v41, s[40:43], s39 offen offset:0 sc1
  buffer_load_dword v143, v41, s[40:43], s39 offen offset:2048 sc1
L_pc26:
  s_waitcnt vmcnt(0)
  v_xor_b32 v128, v45, v128
  v_xor_b32 v129, v45, v129
  v_xor_b32 v130, v45, v130
  v_xor_b32 v131, v45, v131
  v_xor_b32 v132, v45, v132
  v_xor_b32 v133, v45, v133
  v_xor_b32 v134, v45, v134
  v_xor_b32 v135, v45, v135
  v_xor_b32 v136, v45, v136
  v_xor_b32 v137, v45, v137
  v_xor_b32 v138, v45, v138
  v_xor_b32 v139, v45, v139
  v_xor_b32 v140, v45, v140
  v_xor_b32 v141, v45, v141
  v_xor_b32 v142, v45, v142
  v_xor_b32 v143, v45, v143
  v_or3_b32 v46, v128, v129, v130
  v_or3_b32 v46, v46, v131, v132
  v_or3_b32 v46, v46, v133, v134
  v_or3_b32 v46, v46, v135, v136
  v_or3_b32 v46, v46, v137, v138
  v_or3_b32 v46, v46, v139, v140
  v_or3_b32 v46, v46, v141, v142
  v_or_b32 v46, v46, v143
  v_and_b32 v46, 1023, v46
  v_cmp_ne_u32 vcc, 0, v46
  s_cbranch_vccz L_pd25
  s_sleep 1
  s_sub_u32 s60, s60, 1
  s_cmp_lg_u32 s60, 0
  s_cbranch_scc1 L_pl24
L_pd25:
  s_nop 1
  s_waitcnt lgkmcnt(0)
  v_pk_add_f32 v[128:129], v[128:129], v[136:137]
  v_pk_add_f32 v[130:131], v[130:131], v[138:139]
  v_pk_add_f32 v[132:133], v[132:133], v[140:141]
  v_pk_add_f32 v[134:135], v[134:135], v[142:143]
  v_pk_add_f32 v[128:129], v[128:129], v[132:133]
  v_pk_add_f32 v[130:131], v[130:131], v[134:135]
  v_pk_add_f32 v[128:129], v[128:129], v[130:131]
  v_add_f32 v128, v128, v129
  v_mov_b32 v129, v128
  s_nop 1
  v_permlane16_swap_b32 v128, v129
  v_add_f32 v128, v128, v129
  v_mov_b32 v129, v128
  s_nop 1
  v_permlane32_swap_b32 v128, v129
  v_add_f32 v128, v128, v129
  v_cvt_pk_bf16_f32 v129, v128, v128
  v_lshlrev_b32 v128, 16, v129
  v_mul_f32 v128, v128, v48
  v_cvt_pk_bf16_f32 v129, v128, v128
  v_lshlrev_b32 v128, 16, v129
  v_add_f32 v128, v128, v49
  v_cvt_pk_bf16_f32 v128, v128, v128
  s_mov_b64 exec, 0xffff
  buffer_store_short v128, v40, s[52:55], s75 offen sc1
  s_mov_b64 exec, -1
L_fin:
L_end:
  s_endpgm
L_codeend:
.section .rodata,"a"
.p2align 6
.amdhsa_kernel recurrent_scan__gqa_block_cached__dense_activation_squared_relu__decode_kernel
  .amdhsa_next_free_vgpr 256
  .amdhsa_next_free_sgpr 96
  .amdhsa_accum_offset 256
  .amdhsa_group_segment_fixed_size 0
  .amdhsa_kernarg_size 104
  .amdhsa_user_sgpr_count 2
  .amdhsa_user_sgpr_kernarg_segment_ptr 1
  .amdhsa_system_sgpr_workgroup_id_x 1
.end_amdhsa_kernel
```
